```python
import torch

def _softmax(x, axis=-1):
    return torch.softmax(x, dim=axis)
def _gelu(x):
    return torch.nn.functional.gelu(x, approximate="tanh")
def _silu(x):
    return torch.nn.functional.silu(x)
def _sigmoid(x):
    return torch.sigmoid(x)
def _layernorm(x, axis=-1, eps=1e-5):
    m = x.mean(dim=axis, keepdim=True)
    v = x.var(dim=axis, keepdim=True, unbiased=False)
    return (x - m) / torch.sqrt(v + eps)
def _scatter_add(tgt, idx, src, axis=0):
    return tgt.clone().index_add_(axis, idx, src)
def _segment_sum(src, seg, n):
    out = torch.zeros((n,) + src.shape[1:], dtype=src.dtype)
    return out.index_add_(0, seg, src)
def _pad(x, pw):
    flat = tuple(v for pair in reversed(pw) for v in pair)
    return torch.nn.functional.pad(x, flat)

kernel_name = 'sequential_preLN__linear_kernel_hedgehog__moe_arch_mod__prompt'

def setup_inputs():

    _w = (lambda a: (lambda t: t.to(torch.bfloat16) if t.is_floating_point() else t)(torch.as_tensor(a)))
    def _A_setup():
        B, S, D, H = 1, 2048, 576, 32
        Dh = D // H
        return {
            "x": _w((lambda *s: torch.randn(*s, dtype=torch.bfloat16) * 0.05)(B, S, D)),
            "wqkv": _w((lambda *s: torch.randn(*s, dtype=torch.bfloat16) * 0.2)(D, 3 * D)),
            "w_phi": _w((lambda *s: torch.randn(*s, dtype=torch.bfloat16) * 0.2)(H, Dh, Dh) * (Dh ** -0.5)),
            "wo": _w((lambda *s: torch.randn(*s, dtype=torch.bfloat16) * 0.05)(D, D)),
        }
    _A_in = _A_setup()

    def _B_setup():
        B, S, D, F, C = 1, 2048, 576, 4608, 8
        return {
            "x": _w((lambda *s: torch.randn(*s, dtype=torch.bfloat16) * 0.05)(B, S, D)),
            "w_r": _w((lambda *s: torch.randn(*s, dtype=torch.bfloat16) * 0.05)(D)),
            "w_gate": _w((lambda *s: torch.randn(*s, dtype=torch.bfloat16) * 0.05)(D, F)),
            "w_up": _w((lambda *s: torch.randn(*s, dtype=torch.bfloat16) * 0.05)(D, F)),
            "w_down": _w((lambda *s: torch.randn(*s, dtype=torch.bfloat16) * 0.05)(F, D)),
        }
    _B_in = _B_setup()

    return {
        "A_x": _A_in["x"],
        "A_wqkv": _A_in["wqkv"],
        "A_w_phi": _A_in["w_phi"],
        "A_wo": _A_in["wo"],
        "B_x": _B_in["x"],
        "B_w_r": _B_in["w_r"],
        "B_w_gate": _B_in["w_gate"],
        "B_w_up": _B_in["w_up"],
        "B_w_down": _B_in["w_down"],
    }

def reference(A_x, A_wqkv, A_w_phi, A_wo, B_x, B_w_r, B_w_gate, B_w_up, B_w_down):
    def _A_ref(x, wqkv, w_phi, wo):
        B, S, D = x.shape
        H = 32; Dh = D // H
        qkv = (lambda x, *d: x.permute(*d))((x @ wqkv).reshape(B, S, 3, H, Dh), 2, 0, 3, 1, 4)
        q, k, v = qkv[0], qkv[1], qkv[2]
        pq = torch.einsum("bhsd,hdf->bhsf", q, w_phi)
        pk = torch.einsum("bhsd,hdf->bhsf", k, w_phi)
        phi_q = torch.concatenate([_softmax(pq, axis=-1), _softmax(-pq, axis=-1)], axis=-1)
        phi_k = torch.concatenate([_softmax(pk, axis=-1), _softmax(-pk, axis=-1)], axis=-1)
        kv = torch.einsum("bhsf,bhsd->bhfd", phi_k, v)
        z  = torch.einsum("bhsf->bhf", phi_k)
        num = torch.einsum("bhqf,bhfd->bhqd", phi_q, kv)
        den = torch.einsum("bhqf,bhf->bhq", phi_q, z)[..., None] + 1e-6
        o = num / den
        return (lambda x, *d: x.permute(*d))(o, 0, 2, 1, 3).reshape(B, S, D) @ wo

    def _B_ref(x, w_r, w_gate, w_up, w_down):
        B, S, D = x.shape
        C = 8
        r = x @ w_r
        idx = torch.argsort(-r, axis=-1)[:, :C]
        idx_e = (lambda x, n, axis: torch.repeat_interleave(x, n, dim=axis))(idx.reshape(B, C, 1), D, axis=2)
        x_sel = (lambda x, i, axis: torch.take_along_dim(x, i, dim=axis))(x, idx_e, axis=1)
        g = _silu(x_sel @ w_gate)
        u = x_sel @ w_up
        y = (g * u) @ w_down
        r_sel = _sigmoid((lambda x, i, axis: torch.take_along_dim(x, i, dim=axis))(r, idx, axis=1))
        y = y * r_sel.reshape(B, C, 1)
        b_off = (torch.arange(B) * S).reshape(B, 1)
        flat_idx = (idx + b_off).reshape(B * C)
        zero = (x * 0.0).reshape(B * S, D)
        upd = _scatter_add(zero, flat_idx, y.reshape(B * C, D), axis=0)
        return x + upd.reshape(B, S, D)

    x = A_x
    h = x + _A_ref(_layernorm(x, axis=-1), A_wqkv, A_w_phi, A_wo)
    h2 = h + _B_ref(_layernorm(h, axis=-1), B_w_r, B_w_gate, B_w_up, B_w_down)
    return h2
```

```asm
; @launch grid=(256,1,1) block=(512,1,1) lds=163840
.amdgcn_target "amdgcn-amd-amdhsa--gfx950"
.text
.globl sequential_preLN__linear_kernel_hedgehog__moe_arch_mod__prompt_kernel
.p2align 8
.type sequential_preLN__linear_kernel_hedgehog__moe_arch_mod__prompt_kernel,@function
sequential_preLN__linear_kernel_hedgehog__moe_arch_mod__prompt_kernel:
  s_cmp_ge_u32 s2, 256
  s_cbranch_scc1 L_exit0
  s_load_dwordx4 s[64:67], s[0:1], 0
  s_load_dwordx4 s[68:71], s[0:1], 16
  s_load_dwordx16 s[72:87], s[0:1], 32
  v_lshrrev_b32 v12, 6, v0
  v_and_b32 v1, 63, v0
  s_and_b32 s54, s2, 7
  v_readfirstlane_b32 s48, v12
  s_lshr_b32 s55, s2, 3
  v_and_b32 v10, 15, v0
  v_lshrrev_b32 v11, 4, v1
  s_and_b32 s57, s54, 1
  s_lshl_b32 s57, s57, 3
  s_and_b32 s58, s55, 7
  s_add_u32 s50, s57, s58
  s_lshr_b32 s57, s54, 1
  s_lshl_b32 s57, s57, 2
  s_lshr_b32 s59, s55, 3
  s_add_u32 s51, s57, s59
  s_lshl_b32 s59, s59, 1
  s_add_u32 s63, s58, s59
  s_sub_u32 s57, s63, 9
  s_cmp_ge_u32 s63, 9
  s_cselect_b32 s63, s57, s63
  s_mul_i32 s62, s51, 72
  s_and_b32 s56, s62, 15
  s_and_b32 s62, s62, 0xfffffff0
  s_and_b32 s49, s48, 3
  s_cmp_ge_u32 s48, 4
  s_cbranch_scc1 L_V
  s_lshl_b32 s57, s49, 6
  s_add_u32 s57, s57, 0
  v_add_u32 v12, s57, v1
  v_mul_u32_u24 v13, 6554, v12
  v_lshrrev_b32 v13, 16, v13
  v_mul_u32_u24 v14, 10, v13
  v_sub_u32 v14, v12, v14
  v_and_b32 v15, 0xfffffff3, v13
  v_and_b32 v12, 4, v13
  v_lshl_or_b32 v15, v12, 1, v15
  v_and_b32 v12, 8, v13
  v_lshrrev_b32 v12, 1, v12
  v_or_b32 v15, v15, v12
  v_mul_u32_u24 v15, 3456, v15
  v_cmp_lt_u32 vcc, 4, v14
  v_mov_b32 v12, 1152
  v_mov_b32 v13, 2224
  v_cndmask_b32 v12, v12, v13, vcc
  v_lshlrev_b32 v14, 4, v14
  v_add3_u32 v15, v15, v14, v12
  v_add_u32 v4, s62, v15
  s_lshl_b32 s57, s49, 6
  s_add_u32 s57, s57, 256
  v_add_u32 v12, s57, v1
  v_mul_u32_u24 v13, 6554, v12
  v_lshrrev_b32 v13, 16, v13
  v_mul_u32_u24 v14, 10, v13
  v_sub_u32 v14, v12, v14
  v_and_b32 v15, 0xfffffff3, v13
  v_and_b32 v12, 4, v13
  v_lshl_or_b32 v15, v12, 1, v15
  v_and_b32 v12, 8, v13
  v_lshrrev_b32 v12, 1, v12
  v_or_b32 v15, v15, v12
  v_mul_u32_u24 v15, 3456, v15
  v_cmp_lt_u32 vcc, 4, v14
  v_mov_b32 v12, 1152
  v_mov_b32 v13, 2224
  v_cndmask_b32 v12, v12, v13, vcc
  v_lshlrev_b32 v14, 4, v14
  v_add3_u32 v15, v15, v14, v12
  v_add_u32 v156, s62, v15
  s_lshl_b32 s57, s49, 6
  s_add_u32 s57, s57, 512
  v_add_u32 v12, s57, v1
  v_mul_u32_u24 v13, 6554, v12
  v_lshrrev_b32 v13, 16, v13
  v_mul_u32_u24 v14, 10, v13
  v_sub_u32 v14, v12, v14
  v_and_b32 v15, 0xfffffff3, v13
  v_and_b32 v12, 4, v13
  v_lshl_or_b32 v15, v12, 1, v15
  v_and_b32 v12, 8, v13
  v_lshrrev_b32 v12, 1, v12
  v_or_b32 v15, v15, v12
  v_mul_u32_u24 v15, 3456, v15
  v_cmp_lt_u32 vcc, 4, v14
  v_mov_b32 v12, 1152
  v_mov_b32 v13, 2224
  v_cndmask_b32 v12, v12, v13, vcc
  v_lshlrev_b32 v14, 4, v14
  v_add3_u32 v15, v15, v14, v12
  v_add_u32 v157, s62, v15
  s_lshl_b32 s89, s49, 10
  s_cmp_lt_u32 s49, 2
  s_cselect_b32 s94, -1, 0
  s_cselect_b32 s95, -1, 0
  s_waitcnt lgkmcnt(0)
  s_mov_b32 s8, s66
  s_mov_b32 s9, s67
  s_mov_b32 s10, 1990656
  s_mov_b32 s11, 0x20000
  s_lshl_b32 s59, s63, 7
  s_mul_i32 s58, s59, 1728
  s_add_u32 m0, s89, 16384
  s_nop 0
  buffer_load_dwordx4 v4, s[8:11], s58 offen  lds
  s_add_u32 m0, s89, 20480
  s_nop 0
  buffer_load_dwordx4 v156, s[8:11], s58 offen  lds
  s_add_u32 m0, s89, 24576
  s_mov_b64 exec, s[94:95]
  buffer_load_dwordx4 v157, s[8:11], s58 offen  lds
  s_mov_b64 exec, -1
  s_mov_b32 s4, s64
  s_mov_b32 s5, s65
  s_mov_b32 s6, 2359296
  s_mov_b32 s7, 0x20000
  s_mov_b32 s8, s66
  s_mov_b32 s9, s67
  s_mov_b32 s10, 1990656
  s_mov_b32 s11, 0x20000
  s_mov_b32 s36, s68
  s_mov_b32 s37, s69
  s_mov_b32 s38, 20736
  s_mov_b32 s39, 0x20000
  s_mov_b32 s20, s70
  s_mov_b32 s21, s71
  s_mov_b32 s22, 663552
  s_mov_b32 s23, 0x20000
  s_mov_b32 s44, s74
  s_mov_b32 s45, s75
  s_mov_b32 s46, 1152
  s_mov_b32 s47, 0x20000
  s_mov_b32 s24, s76
  s_mov_b32 s25, s77
  s_mov_b32 s26, 5308416
  s_mov_b32 s27, 0x20000
  s_mov_b32 s28, s78
  s_mov_b32 s29, s79
  s_mov_b32 s30, 5308416
  s_mov_b32 s31, 0x20000
  s_mov_b32 s32, s80
  s_mov_b32 s33, s81
  s_mov_b32 s34, 5308416
  s_mov_b32 s35, 0x20000
  s_mov_b32 s16, s82
  s_mov_b32 s17, s83
  s_mov_b32 s18, 2359296
  s_mov_b32 s19, 0x20000
  s_mov_b32 s40, s84
  s_mov_b32 s41, s85
  s_mov_b32 s42, 256
  s_mov_b32 s43, 0x20000
  s_mov_b32 s12, s86
  s_mov_b32 s13, s87
  s_mov_b32 s14, 268435456
  s_mov_b32 s15, 0x20000
  s_mul_i32 s57, s51, 1296
  v_lshlrev_b32 v12, 2, v0
  v_cmp_gt_u32 vcc, 324, v0
  v_mov_b32 v13, 0x7fffffff
  s_nop 0
  v_cndmask_b32 v12, v13, v12, vcc
  buffer_load_dword v74, v12, s[36:39], s57 offen
  s_mov_b32 s82, s94
  s_mov_b32 s83, s95
  s_add_u32 s64, s63, 0
  s_sub_u32 s57, s64, 9
  s_cmp_ge_u32 s64, 9
  s_cselect_b32 s64, s57, s64
  s_lshl_b32 s64, s64, 7
  s_add_u32 s73, s64, 18432
  s_add_u32 s65, s63, 1
  s_sub_u32 s57, s65, 9
  s_cmp_ge_u32 s65, 9
  s_cselect_b32 s65, s57, s65
  s_lshl_b32 s65, s65, 7
  s_add_u32 s74, s65, 18432
  s_add_u32 s66, s63, 2
  s_sub_u32 s57, s66, 9
  s_cmp_ge_u32 s66, 9
  s_cselect_b32 s66, s57, s66
  s_lshl_b32 s66, s66, 7
  s_add_u32 s75, s66, 18432
  s_add_u32 s67, s63, 3
  s_sub_u32 s57, s67, 9
  s_cmp_ge_u32 s67, 9
  s_cselect_b32 s67, s57, s67
  s_lshl_b32 s67, s67, 7
  s_add_u32 s76, s67, 18432
  s_add_u32 s68, s63, 4
  s_sub_u32 s57, s68, 9
  s_cmp_ge_u32 s68, 9
  s_cselect_b32 s68, s57, s68
  s_lshl_b32 s68, s68, 7
  s_add_u32 s77, s68, 18432
  s_add_u32 s69, s63, 5
  s_sub_u32 s57, s69, 9
  s_cmp_ge_u32 s69, 9
  s_cselect_b32 s69, s57, s69
  s_lshl_b32 s69, s69, 7
  s_add_u32 s78, s69, 18432
  s_add_u32 s70, s63, 6
  s_sub_u32 s57, s70, 9
  s_cmp_ge_u32 s70, 9
  s_cselect_b32 s70, s57, s70
  s_lshl_b32 s70, s70, 7
  s_add_u32 s79, s70, 18432
  s_add_u32 s71, s63, 7
  s_sub_u32 s57, s71, 9
  s_cmp_ge_u32 s71, 9
  s_cselect_b32 s71, s57, s71
  s_lshl_b32 s71, s71, 7
  s_add_u32 s80, s71, 18432
  s_add_u32 s72, s63, 8
  s_sub_u32 s57, s72, 9
  s_cmp_ge_u32 s72, 9
  s_cselect_b32 s72, s57, s72
  s_lshl_b32 s72, s72, 7
  s_add_u32 s81, s72, 18432
  v_mov_b32 v80, 0
  v_mov_b32 v81, 0
  v_mov_b32 v82, 0
  v_mov_b32 v83, 0
  v_lshlrev_b32 v12, 4, v0
  v_add_u32 v12, 159744, v12
  ds_write_b128 v12, v[80:83]
  s_lshl_b32 s57, s54, 3
  s_lshr_b32 s58, s55, 2
  s_add_u32 s52, s57, s58
  s_and_b32 s53, s55, 3
  s_lshl_b32 s57, s49, 5
  v_add_u32 v12, s57, v10
  v_lshlrev_b32 v12, 7, v12
  v_lshrrev_b32 v13, 1, v10
  v_xor_b32 v13, v13, v11
  v_lshlrev_b32 v13, 4, v13
  v_add_u32 v6, v12, v13
  v_xor_b32 v7, 64, v6
  v_lshrrev_b32 v12, 1, v11
  v_lshlrev_b32 v12, 4, v12
  v_and_b32 v13, 1, v11
  v_lshlrev_b32 v13, 2, v13
  v_lshrrev_b32 v14, 2, v10
  v_add3_u32 v75, v12, v13, v14
  v_and_b32 v13, 3, v1
  v_mul_u32_u24 v14, 160, v75
  v_add_u32 v14, s56, v14
  v_lshlrev_b32 v15, 3, v13
  v_add_u32 v8, v14, v15
  v_cmp_eq_u32 vcc, 1, v13
  v_mov_b32 v15, 64
  v_mov_b32 v12, 112
  v_cndmask_b32 v15, v15, v12, vcc
  v_add_u32 v9, v14, v15
  s_mov_b32 s90, 0x01000100
  s_mov_b32 s91, 0x01000100
  v_mov_b32 v52, 0x3f803f80
  v_mov_b32 v53, 0x3f803f80
  v_mov_b32 v54, 0x3f803f80
  v_mov_b32 v55, 0x3f803f80
  s_mov_b32 s92, 0x3fb8aa3b
  s_mul_i32 s58, s65, 1728
  s_add_u32 m0, s89, 43008
  s_nop 0
  buffer_load_dwordx4 v4, s[8:11], s58 offen  lds
  s_add_u32 m0, s89, 47104
  s_nop 0
  buffer_load_dwordx4 v156, s[8:11], s58 offen  lds
  s_add_u32 m0, s89, 51200
  s_mov_b64 exec, s[82:83]
  buffer_load_dwordx4 v157, s[8:11], s58 offen  lds
  s_mov_b64 exec, -1
  s_waitcnt vmcnt(3)
  s_waitcnt lgkmcnt(0)
  s_barrier
  v_cmp_lt_u32 vcc, 161, v0
  v_mov_b32 v12, 0
  v_mov_b32 v13, 162
  v_cndmask_b32 v12, v12, v13, vcc
  v_sub_u32 v12, v0, v12
  v_mov_b32 v14, 0
  v_mov_b32 v13, 18
  v_cndmask_b32 v13, v14, v13, vcc
  v_mul_u32_u24 v14, 57, v12
  v_lshrrev_b32 v14, 9, v14
  v_mul_u32_u24 v15, 9, v14
  v_sub_u32 v15, v12, v15
  v_lshl_add_u32 v15, v15, 1, v13
  v_mul_u32_u24 v15, 96, v15
  v_add_u32 v14, v14, v13
  v_lshl_add_u32 v15, v14, 1, v15
  v_add_u32 v15, 159744, v15
  v_cmp_gt_u32 vcc, 324, v0
  s_nop 0
  s_and_saveexec_b64 s[94:95], vcc
  s_cbranch_execz L_ws_1
  ds_write_b16 v15, v74
  ds_write_b16_d16_hi v15, v74 offset:96
L_ws_1:
  s_mov_b64 exec, s[94:95]
  ds_read_b128 v[76:79], v6 offset:0
  ds_read_b128 v[80:83], v6 offset:2048
  ds_read_b64_tr_b16 v[108:109], v8 offset:16384
  ds_read_b64_tr_b16 v[110:111], v8 offset:17664
  ds_read_b64_tr_b16 v[112:113], v8 offset:16416
  ds_read_b64_tr_b16 v[114:115], v8 offset:17696
  ds_read_b64_tr_b16 v[116:117], v9 offset:16384
  ds_read_b64_tr_b16 v[118:119], v9 offset:17664
  ds_read_b128 v[84:87], v7 offset:0
  ds_read_b128 v[88:91], v7 offset:2048
  ds_read_b64_tr_b16 v[120:121], v8 offset:21504
  ds_read_b64_tr_b16 v[122:123], v8 offset:22784
  ds_read_b64_tr_b16 v[124:125], v8 offset:21536
  ds_read_b64_tr_b16 v[126:127], v8 offset:22816
  ds_read_b64_tr_b16 v[128:129], v9 offset:21504
  ds_read_b64_tr_b16 v[130:131], v9 offset:22784
  s_mul_i32 s58, s66, 1728
  s_add_u32 m0, s89, 69632
  s_nop 0
  buffer_load_dwordx4 v4, s[8:11], s58 offen  lds
  s_add_u32 m0, s89, 73728
  s_nop 0
  buffer_load_dwordx4 v156, s[8:11], s58 offen  lds
  s_add_u32 m0, s89, 77824
  s_mov_b64 exec, s[82:83]
  buffer_load_dwordx4 v157, s[8:11], s58 offen  lds
  s_mov_b64 exec, -1
  s_waitcnt lgkmcnt(0)
  s_waitcnt vmcnt(3)
  s_barrier
  v_add_u32 v6, 26624, v6
  v_add_u32 v7, 26624, v7
  v_add_u32 v8, 26624, v8
  v_add_u32 v9, 26624, v9
  v_cndmask_b32_e64 v116, v116, v52, s[90:91]
  v_cndmask_b32_e64 v117, v117, v52, s[90:91]
  v_cndmask_b32_e64 v118, v118, v52, s[90:91]
  v_cndmask_b32_e64 v119, v119, v52, s[90:91]
  v_cndmask_b32_e64 v128, v128, v52, s[90:91]
  v_cndmask_b32_e64 v129, v129, v52, s[90:91]
  v_cndmask_b32_e64 v130, v130, v52, s[90:91]
  v_cndmask_b32_e64 v131, v131, v52, s[90:91]
  v_mfma_f32_16x16x32_bf16 v[16:19], v[108:111], v[76:79], 0
  ds_read_b128 v[92:95], v6 offset:0
  ds_read_b128 v[96:99], v6 offset:2048
  v_mfma_f32_16x16x32_bf16 v[20:23], v[108:111], v[80:83], 0
  ds_read_b64_tr_b16 v[132:133], v8 offset:16384
  v_mfma_f32_16x16x32_bf16 v[40:43], v[108:111], v[52:55], 0
  ds_read_b64_tr_b16 v[134:135], v8 offset:17664
  ds_read_b64_tr_b16 v[136:137], v8 offset:16416
  v_mfma_f32_16x16x32_bf16 v[24:27], v[112:115], v[76:79], 0
  ds_read_b64_tr_b16 v[138:139], v8 offset:17696
  v_mfma_f32_16x16x32_bf16 v[28:31], v[112:115], v[80:83], 0
  ds_read_b64_tr_b16 v[140:141], v9 offset:16384
  ds_read_b64_tr_b16 v[142:143], v9 offset:17664
  v_mfma_f32_16x16x32_bf16 v[44:47], v[112:115], v[52:55], 0
  ds_read_b128 v[100:103], v7 offset:0
  v_mfma_f32_16x16x32_bf16 v[32:35], v[116:119], v[76:79], 0
  ds_read_b128 v[104:107], v7 offset:2048
  ds_read_b64_tr_b16 v[144:145], v8 offset:21504
  v_mfma_f32_16x16x32_bf16 v[36:39], v[116:119], v[80:83], 0
  ds_read_b64_tr_b16 v[146:147], v8 offset:22784
  v_mfma_f32_16x16x32_bf16 v[48:51], v[116:119], v[52:55], 0
  ds_read_b64_tr_b16 v[148:149], v8 offset:21536
  ds_read_b64_tr_b16 v[150:151], v8 offset:22816
  v_mfma_f32_16x16x32_bf16 v[16:19], v[120:123], v[84:87], v[16:19]
  ds_read_b64_tr_b16 v[152:153], v9 offset:21504
  v_mfma_f32_16x16x32_bf16 v[20:23], v[120:123], v[88:91], v[20:23]
  ds_read_b64_tr_b16 v[154:155], v9 offset:22784
  v_mfma_f32_16x16x32_bf16 v[40:43], v[120:123], v[52:55], v[40:43]
  s_mul_i32 s58, s67, 1728
  s_add_u32 m0, s89, 96256
  s_nop 0
  buffer_load_dwordx4 v4, s[8:11], s58 offen  lds
  v_mfma_f32_16x16x32_bf16 v[24:27], v[124:127], v[84:87], v[24:27]
  v_mfma_f32_16x16x32_bf16 v[28:31], v[124:127], v[88:91], v[28:31]
  s_add_u32 m0, s89, 100352
  s_nop 0
  buffer_load_dwordx4 v156, s[8:11], s58 offen  lds
  v_mfma_f32_16x16x32_bf16 v[44:47], v[124:127], v[52:55], v[44:47]
  v_mfma_f32_16x16x32_bf16 v[32:35], v[128:131], v[84:87], v[32:35]
  s_add_u32 m0, s89, 104448
  s_mov_b64 exec, s[82:83]
  buffer_load_dwordx4 v157, s[8:11], s58 offen  lds
  s_mov_b64 exec, -1
  v_mfma_f32_16x16x32_bf16 v[36:39], v[128:131], v[88:91], v[36:39]
  v_mfma_f32_16x16x32_bf16 v[48:51], v[128:131], v[52:55], v[48:51]
  v_and_b32 v12, 7, v10
  v_add_u32 v12, 0, v12
  v_lshrrev_b32 v13, 3, v10
  v_mul_u32_u24 v13, 18, v13
  v_add_u32 v13, v13, v12
  v_cmp_gt_u32 vcc, 18, v12
  v_mov_b32 v14, 36
  s_nop 0
  v_cndmask_b32 v13, v14, v13, vcc
  v_mul_u32_u24 v13, 96, v13
  v_lshl_add_u32 v13, v11, 3, v13
  v_add_u32 v13, 159744, v13
  ds_read_b64 v[56:57], v13
  ds_read_b64 v[58:59], v13 offset:32
  ds_read_b64 v[60:61], v13 offset:64
  v_and_b32 v12, 7, v10
  v_add_u32 v12, 8, v12
  v_lshrrev_b32 v13, 3, v10
  v_mul_u32_u24 v13, 18, v13
  v_add_u32 v13, v13, v12
  v_cmp_gt_u32 vcc, 18, v12
  v_mov_b32 v14, 36
  s_nop 0
  v_cndmask_b32 v13, v14, v13, vcc
  v_mul_u32_u24 v13, 96, v13
  v_lshl_add_u32 v13, v11, 3, v13
  v_add_u32 v13, 159744, v13
  ds_read_b64 v[62:63], v13
  ds_read_b64 v[64:65], v13 offset:32
  ds_read_b64 v[66:67], v13 offset:64
  v_and_b32 v12, 7, v10
  v_add_u32 v12, 16, v12
  v_lshrrev_b32 v13, 3, v10
  v_mul_u32_u24 v13, 18, v13
  v_add_u32 v13, v13, v12
  v_cmp_gt_u32 vcc, 18, v12
  v_mov_b32 v14, 36
  s_nop 0
  v_cndmask_b32 v13, v14, v13, vcc
  v_mul_u32_u24 v13, 96, v13
  v_lshl_add_u32 v13, v11, 3, v13
  v_add_u32 v13, 159744, v13
  ds_read_b64 v[68:69], v13
  ds_read_b64 v[70:71], v13 offset:32
  ds_read_b64 v[72:73], v13 offset:64
  s_waitcnt lgkmcnt(0)
  s_waitcnt vmcnt(3)
  s_barrier
  v_add_u32 v6, 26624, v6
  v_add_u32 v7, 26624, v7
  v_add_u32 v8, 26624, v8
  v_add_u32 v9, 26624, v9
  v_cndmask_b32_e64 v140, v140, v52, s[90:91]
  v_cndmask_b32_e64 v141, v141, v52, s[90:91]
  v_cndmask_b32_e64 v142, v142, v52, s[90:91]
  v_cndmask_b32_e64 v143, v143, v52, s[90:91]
  v_cndmask_b32_e64 v152, v152, v52, s[90:91]
  v_cndmask_b32_e64 v153, v153, v52, s[90:91]
  v_cndmask_b32_e64 v154, v154, v52, s[90:91]
  v_cndmask_b32_e64 v155, v155, v52, s[90:91]
  v_mfma_f32_16x16x32_bf16 v[16:19], v[132:135], v[92:95], v[16:19]
  ds_read_b128 v[76:79], v6 offset:0
  ds_read_b128 v[80:83], v6 offset:2048
  v_mfma_f32_16x16x32_bf16 v[20:23], v[132:135], v[96:99], v[20:23]
  ds_read_b64_tr_b16 v[108:109], v8 offset:16384
  v_mfma_f32_16x16x32_bf16 v[40:43], v[132:135], v[52:55], v[40:43]
  ds_read_b64_tr_b16 v[110:111], v8 offset:17664
  ds_read_b64_tr_b16 v[112:113], v8 offset:16416
  v_mfma_f32_16x16x32_bf16 v[24:27], v[136:139], v[92:95], v[24:27]
  ds_read_b64_tr_b16 v[114:115], v8 offset:17696
  v_mfma_f32_16x16x32_bf16 v[28:31], v[136:139], v[96:99], v[28:31]
  ds_read_b64_tr_b16 v[116:117], v9 offset:16384
  ds_read_b64_tr_b16 v[118:119], v9 offset:17664
  v_mfma_f32_16x16x32_bf16 v[44:47], v[136:139], v[52:55], v[44:47]
  ds_read_b128 v[84:87], v7 offset:0
  v_mfma_f32_16x16x32_bf16 v[32:35], v[140:143], v[92:95], v[32:35]
  ds_read_b128 v[88:91], v7 offset:2048
  ds_read_b64_tr_b16 v[120:121], v8 offset:21504
  v_mfma_f32_16x16x32_bf16 v[36:39], v[140:143], v[96:99], v[36:39]
  ds_read_b64_tr_b16 v[122:123], v8 offset:22784
  v_mfma_f32_16x16x32_bf16 v[48:51], v[140:143], v[52:55], v[48:51]
  ds_read_b64_tr_b16 v[124:125], v8 offset:21536
  ds_read_b64_tr_b16 v[126:127], v8 offset:22816
  v_mfma_f32_16x16x32_bf16 v[16:19], v[144:147], v[100:103], v[16:19]
  ds_read_b64_tr_b16 v[128:129], v9 offset:21504
  v_mfma_f32_16x16x32_bf16 v[20:23], v[144:147], v[104:107], v[20:23]
  ds_read_b64_tr_b16 v[130:131], v9 offset:22784
  v_mfma_f32_16x16x32_bf16 v[40:43], v[144:147], v[52:55], v[40:43]
  s_mul_i32 s58, s68, 1728
  s_add_u32 m0, s89, 16384
  s_nop 0
  buffer_load_dwordx4 v4, s[8:11], s58 offen  lds
  v_mfma_f32_16x16x32_bf16 v[24:27], v[148:151], v[100:103], v[24:27]
  v_mfma_f32_16x16x32_bf16 v[28:31], v[148:151], v[104:107], v[28:31]
  s_add_u32 m0, s89, 20480
  s_nop 0
  buffer_load_dwordx4 v156, s[8:11], s58 offen  lds
  v_mfma_f32_16x16x32_bf16 v[44:47], v[148:151], v[52:55], v[44:47]
  v_mfma_f32_16x16x32_bf16 v[32:35], v[152:155], v[100:103], v[32:35]
  s_add_u32 m0, s89, 24576
  s_mov_b64 exec, s[82:83]
  buffer_load_dwordx4 v157, s[8:11], s58 offen  lds
  s_mov_b64 exec, -1
  v_mfma_f32_16x16x32_bf16 v[36:39], v[152:155], v[104:107], v[36:39]
  v_mfma_f32_16x16x32_bf16 v[48:51], v[152:155], v[52:55], v[48:51]
  v_mov_b32 v160, -1
  v_mov_b32 v161, -1
  v_mov_b32 v162, -1
  v_mov_b32 v163, -1
  v_lshlrev_b32 v12, 4, v1
  s_mul_i32 s57, s2, 14336
  s_lshl_b32 s58, s49, 10
  s_add_u32 s57, s57, s58
  s_mul_i32 s59, s2, 9216
  buffer_store_dwordx4 v[160:163], v12, s[12:15], s57 offen sc1
  s_add_u32 s57, s57, 4096
  buffer_store_dwordx4 v[160:163], v12, s[12:15], s57 offen sc1
  s_add_u32 s57, s57, 4096
  buffer_store_dwordx4 v[160:163], v12, s[12:15], s57 offen sc1
  s_add_u32 s57, s57, 4096
  s_cmp_lt_u32 s49, 2
  s_cbranch_scc0 L_p_2
  buffer_store_dwordx4 v[160:163], v12, s[12:15], s57 offen sc1
  s_branch L_p_3
L_p_2:
  s_sub_u32 s57, s49, 2
  s_lshl_b32 s57, s57, 10
  s_add_u32 s57, s57, s59
  buffer_store_dwordx4 v[160:163], v12, s[16:19], s57 offen sc1
L_p_3:
  s_add_u32 s57, s49, 2
  s_min_u32 s57, s57, 8
  s_lshl_b32 s57, s57, 10
  s_add_u32 s57, s57, s59
  buffer_store_dwordx4 v[160:163], v12, s[16:19], s57 offen sc1
  s_add_u32 s57, s49, 6
  s_min_u32 s57, s57, 8
  s_lshl_b32 s57, s57, 10
  s_add_u32 s57, s57, s59
  buffer_store_dwordx4 v[160:163], v12, s[16:19], s57 offen sc1
  s_waitcnt lgkmcnt(0)
  s_waitcnt vmcnt(9)
  s_barrier
  v_add_u32 v6, 26624, v6
  v_add_u32 v7, 26624, v7
  v_add_u32 v8, 26624, v8
  v_add_u32 v9, 26624, v9
  v_cndmask_b32_e64 v116, v116, v52, s[90:91]
  v_cndmask_b32_e64 v117, v117, v52, s[90:91]
  v_cndmask_b32_e64 v118, v118, v52, s[90:91]
  v_cndmask_b32_e64 v119, v119, v52, s[90:91]
  v_cndmask_b32_e64 v128, v128, v52, s[90:91]
  v_cndmask_b32_e64 v129, v129, v52, s[90:91]
  v_cndmask_b32_e64 v130, v130, v52, s[90:91]
  v_cndmask_b32_e64 v131, v131, v52, s[90:91]
  v_mfma_f32_16x16x32_bf16 v[16:19], v[108:111], v[76:79], v[16:19]
  ds_read_b128 v[92:95], v6 offset:0
  ds_read_b128 v[96:99], v6 offset:2048
  v_mfma_f32_16x16x32_bf16 v[20:23], v[108:111], v[80:83], v[20:23]
  ds_read_b64_tr_b16 v[132:133], v8 offset:16384
  v_mfma_f32_16x16x32_bf16 v[40:43], v[108:111], v[52:55], v[40:43]
  ds_read_b64_tr_b16 v[134:135], v8 offset:17664
  ds_read_b64_tr_b16 v[136:137], v8 offset:16416
  v_mfma_f32_16x16x32_bf16 v[24:27], v[112:115], v[76:79], v[24:27]
  ds_read_b64_tr_b16 v[138:139], v8 offset:17696
  v_mfma_f32_16x16x32_bf16 v[28:31], v[112:115], v[80:83], v[28:31]
  ds_read_b64_tr_b16 v[140:141], v9 offset:16384
  ds_read_b64_tr_b16 v[142:143], v9 offset:17664
  v_mfma_f32_16x16x32_bf16 v[44:47], v[112:115], v[52:55], v[44:47]
  ds_read_b128 v[100:103], v7 offset:0
  v_mfma_f32_16x16x32_bf16 v[32:35], v[116:119], v[76:79], v[32:35]
  ds_read_b128 v[104:107], v7 offset:2048
  ds_read_b64_tr_b16 v[144:145], v8 offset:21504
  v_mfma_f32_16x16x32_bf16 v[36:39], v[116:119], v[80:83], v[36:39]
  ds_read_b64_tr_b16 v[146:147], v8 offset:22784
  v_mfma_f32_16x16x32_bf16 v[48:51], v[116:119], v[52:55], v[48:51]
  ds_read_b64_tr_b16 v[148:149], v8 offset:21536
  ds_read_b64_tr_b16 v[150:151], v8 offset:22816
  v_mfma_f32_16x16x32_bf16 v[16:19], v[120:123], v[84:87], v[16:19]
  ds_read_b64_tr_b16 v[152:153], v9 offset:21504
  v_mfma_f32_16x16x32_bf16 v[20:23], v[120:123], v[88:91], v[20:23]
  ds_read_b64_tr_b16 v[154:155], v9 offset:22784
  v_mfma_f32_16x16x32_bf16 v[40:43], v[120:123], v[52:55], v[40:43]
  s_mul_i32 s58, s69, 1728
  s_add_u32 m0, s89, 43008
  s_nop 0
  buffer_load_dwordx4 v4, s[8:11], s58 offen  lds
  v_mfma_f32_16x16x32_bf16 v[24:27], v[124:127], v[84:87], v[24:27]
  v_mfma_f32_16x16x32_bf16 v[28:31], v[124:127], v[88:91], v[28:31]
  s_add_u32 m0, s89, 47104
  s_nop 0
  buffer_load_dwordx4 v156, s[8:11], s58 offen  lds
  v_mfma_f32_16x16x32_bf16 v[44:47], v[124:127], v[52:55], v[44:47]
  v_mfma_f32_16x16x32_bf16 v[32:35], v[128:131], v[84:87], v[32:35]
  s_add_u32 m0, s89, 51200
  s_mov_b64 exec, s[82:83]
  buffer_load_dwordx4 v157, s[8:11], s58 offen  lds
  s_mov_b64 exec, -1
  v_mfma_f32_16x16x32_bf16 v[36:39], v[128:131], v[88:91], v[36:39]
  v_mfma_f32_16x16x32_bf16 v[48:51], v[128:131], v[52:55], v[48:51]
  s_waitcnt lgkmcnt(0)
  s_waitcnt vmcnt(9)
  s_barrier
  v_add_u32 v6, 4294887424, v6
  v_add_u32 v7, 4294887424, v7
  v_add_u32 v8, 4294887424, v8
  v_add_u32 v9, 4294887424, v9
  v_cndmask_b32_e64 v140, v140, v52, s[90:91]
  v_cndmask_b32_e64 v141, v141, v52, s[90:91]
  v_cndmask_b32_e64 v142, v142, v52, s[90:91]
  v_cndmask_b32_e64 v143, v143, v52, s[90:91]
  v_cndmask_b32_e64 v152, v152, v52, s[90:91]
  v_cndmask_b32_e64 v153, v153, v52, s[90:91]
  v_cndmask_b32_e64 v154, v154, v52, s[90:91]
  v_cndmask_b32_e64 v155, v155, v52, s[90:91]
  v_mfma_f32_16x16x32_bf16 v[16:19], v[132:135], v[92:95], v[16:19]
  ds_read_b128 v[76:79], v6 offset:0
  ds_read_b128 v[80:83], v6 offset:2048
  v_mfma_f32_16x16x32_bf16 v[20:23], v[132:135], v[96:99], v[20:23]
  ds_read_b64_tr_b16 v[108:109], v8 offset:16384
  v_mfma_f32_16x16x32_bf16 v[40:43], v[132:135], v[52:55], v[40:43]
  ds_read_b64_tr_b16 v[110:111], v8 offset:17664
  ds_read_b64_tr_b16 v[112:113], v8 offset:16416
  v_mfma_f32_16x16x32_bf16 v[24:27], v[136:139], v[92:95], v[24:27]
  ds_read_b64_tr_b16 v[114:115], v8 offset:17696
  v_mfma_f32_16x16x32_bf16 v[28:31], v[136:139], v[96:99], v[28:31]
  ds_read_b64_tr_b16 v[116:117], v9 offset:16384
  ds_read_b64_tr_b16 v[118:119], v9 offset:17664
  v_mfma_f32_16x16x32_bf16 v[44:47], v[136:139], v[52:55], v[44:47]
  ds_read_b128 v[84:87], v7 offset:0
  v_mfma_f32_16x16x32_bf16 v[32:35], v[140:143], v[92:95], v[32:35]
  ds_read_b128 v[88:91], v7 offset:2048
  ds_read_b64_tr_b16 v[120:121], v8 offset:21504
  v_mfma_f32_16x16x32_bf16 v[36:39], v[140:143], v[96:99], v[36:39]
  ds_read_b64_tr_b16 v[122:123], v8 offset:22784
  v_mfma_f32_16x16x32_bf16 v[48:51], v[140:143], v[52:55], v[48:51]
  ds_read_b64_tr_b16 v[124:125], v8 offset:21536
  ds_read_b64_tr_b16 v[126:127], v8 offset:22816
  v_mfma_f32_16x16x32_bf16 v[16:19], v[144:147], v[100:103], v[16:19]
  ds_read_b64_tr_b16 v[128:129], v9 offset:21504
  v_mfma_f32_16x16x32_bf16 v[20:23], v[144:147], v[104:107], v[20:23]
  ds_read_b64_tr_b16 v[130:131], v9 offset:22784
  v_mfma_f32_16x16x32_bf16 v[40:43], v[144:147], v[52:55], v[40:43]
  s_mul_i32 s58, s70, 1728
  s_add_u32 m0, s89, 69632
  s_nop 0
  buffer_load_dwordx4 v4, s[8:11], s58 offen  lds
  v_mfma_f32_16x16x32_bf16 v[24:27], v[148:151], v[100:103], v[24:27]
  v_mfma_f32_16x16x32_bf16 v[28:31], v[148:151], v[104:107], v[28:31]
  s_add_u32 m0, s89, 73728
  s_nop 0
  buffer_load_dwordx4 v156, s[8:11], s58 offen  lds
  v_mfma_f32_16x16x32_bf16 v[44:47], v[148:151], v[52:55], v[44:47]
  v_mfma_f32_16x16x32_bf16 v[32:35], v[152:155], v[100:103], v[32:35]
  s_add_u32 m0, s89, 77824
  s_mov_b64 exec, s[82:83]
  buffer_load_dwordx4 v157, s[8:11], s58 offen  lds
  s_mov_b64 exec, -1
  v_mfma_f32_16x16x32_bf16 v[36:39], v[152:155], v[104:107], v[36:39]
  v_mfma_f32_16x16x32_bf16 v[48:51], v[152:155], v[52:55], v[48:51]
  s_waitcnt lgkmcnt(0)
  s_waitcnt vmcnt(3)
  s_barrier
  v_add_u32 v6, 26624, v6
  v_add_u32 v7, 26624, v7
  v_add_u32 v8, 26624, v8
  v_add_u32 v9, 26624, v9
  v_cndmask_b32_e64 v116, v116, v52, s[90:91]
  v_cndmask_b32_e64 v117, v117, v52, s[90:91]
  v_cndmask_b32_e64 v118, v118, v52, s[90:91]
  v_cndmask_b32_e64 v119, v119, v52, s[90:91]
  v_cndmask_b32_e64 v128, v128, v52, s[90:91]
  v_cndmask_b32_e64 v129, v129, v52, s[90:91]
  v_cndmask_b32_e64 v130, v130, v52, s[90:91]
  v_cndmask_b32_e64 v131, v131, v52, s[90:91]
  v_mfma_f32_16x16x32_bf16 v[16:19], v[108:111], v[76:79], v[16:19]
  ds_read_b128 v[92:95], v6 offset:0
  ds_read_b128 v[96:99], v6 offset:2048
  v_mfma_f32_16x16x32_bf16 v[20:23], v[108:111], v[80:83], v[20:23]
  ds_read_b64_tr_b16 v[132:133], v8 offset:16384
  v_mfma_f32_16x16x32_bf16 v[40:43], v[108:111], v[52:55], v[40:43]
  ds_read_b64_tr_b16 v[134:135], v8 offset:17664
  ds_read_b64_tr_b16 v[136:137], v8 offset:16416
  v_mfma_f32_16x16x32_bf16 v[24:27], v[112:115], v[76:79], v[24:27]
  ds_read_b64_tr_b16 v[138:139], v8 offset:17696
  v_mfma_f32_16x16x32_bf16 v[28:31], v[112:115], v[80:83], v[28:31]
  ds_read_b64_tr_b16 v[140:141], v9 offset:16384
  ds_read_b64_tr_b16 v[142:143], v9 offset:17664
  v_mfma_f32_16x16x32_bf16 v[44:47], v[112:115], v[52:55], v[44:47]
  ds_read_b128 v[100:103], v7 offset:0
  v_mfma_f32_16x16x32_bf16 v[32:35], v[116:119], v[76:79], v[32:35]
  ds_read_b128 v[104:107], v7 offset:2048
  ds_read_b64_tr_b16 v[144:145], v8 offset:21504
  v_mfma_f32_16x16x32_bf16 v[36:39], v[116:119], v[80:83], v[36:39]
  ds_read_b64_tr_b16 v[146:147], v8 offset:22784
  v_mfma_f32_16x16x32_bf16 v[48:51], v[116:119], v[52:55], v[48:51]
  ds_read_b64_tr_b16 v[148:149], v8 offset:21536
  ds_read_b64_tr_b16 v[150:151], v8 offset:22816
  v_mfma_f32_16x16x32_bf16 v[16:19], v[120:123], v[84:87], v[16:19]
  ds_read_b64_tr_b16 v[152:153], v9 offset:21504
  v_mfma_f32_16x16x32_bf16 v[20:23], v[120:123], v[88:91], v[20:23]
  ds_read_b64_tr_b16 v[154:155], v9 offset:22784
  v_mfma_f32_16x16x32_bf16 v[40:43], v[120:123], v[52:55], v[40:43]
  s_mul_i32 s58, s71, 1728
  s_add_u32 m0, s89, 96256
  s_nop 0
  buffer_load_dwordx4 v4, s[8:11], s58 offen  lds
  v_mfma_f32_16x16x32_bf16 v[24:27], v[124:127], v[84:87], v[24:27]
  v_mfma_f32_16x16x32_bf16 v[28:31], v[124:127], v[88:91], v[28:31]
  s_add_u32 m0, s89, 100352
  s_nop 0
  buffer_load_dwordx4 v156, s[8:11], s58 offen  lds
  v_mfma_f32_16x16x32_bf16 v[44:47], v[124:127], v[52:55], v[44:47]
  v_mfma_f32_16x16x32_bf16 v[32:35], v[128:131], v[84:87], v[32:35]
  s_add_u32 m0, s89, 104448
  s_mov_b64 exec, s[82:83]
  buffer_load_dwordx4 v157, s[8:11], s58 offen  lds
  s_mov_b64 exec, -1
  v_mfma_f32_16x16x32_bf16 v[36:39], v[128:131], v[88:91], v[36:39]
  v_mfma_f32_16x16x32_bf16 v[48:51], v[128:131], v[52:55], v[48:51]
  s_waitcnt lgkmcnt(0)
  s_waitcnt vmcnt(3)
  s_barrier
  v_add_u32 v6, 26624, v6
  v_add_u32 v7, 26624, v7
  v_add_u32 v8, 26624, v8
  v_add_u32 v9, 26624, v9
  v_cndmask_b32_e64 v140, v140, v52, s[90:91]
  v_cndmask_b32_e64 v141, v141, v52, s[90:91]
  v_cndmask_b32_e64 v142, v142, v52, s[90:91]
  v_cndmask_b32_e64 v143, v143, v52, s[90:91]
  v_cndmask_b32_e64 v152, v152, v52, s[90:91]
  v_cndmask_b32_e64 v153, v153, v52, s[90:91]
  v_cndmask_b32_e64 v154, v154, v52, s[90:91]
  v_cndmask_b32_e64 v155, v155, v52, s[90:91]
  v_mfma_f32_16x16x32_bf16 v[16:19], v[132:135], v[92:95], v[16:19]
  ds_read_b128 v[76:79], v6 offset:0
  ds_read_b128 v[80:83], v6 offset:2048
  v_mfma_f32_16x16x32_bf16 v[20:23], v[132:135], v[96:99], v[20:23]
  ds_read_b64_tr_b16 v[108:109], v8 offset:16384
  v_mfma_f32_16x16x32_bf16 v[40:43], v[132:135], v[52:55], v[40:43]
  ds_read_b64_tr_b16 v[110:111], v8 offset:17664
  ds_read_b64_tr_b16 v[112:113], v8 offset:16416
  v_mfma_f32_16x16x32_bf16 v[24:27], v[136:139], v[92:95], v[24:27]
  ds_read_b64_tr_b16 v[114:115], v8 offset:17696
  v_mfma_f32_16x16x32_bf16 v[28:31], v[136:139], v[96:99], v[28:31]
  ds_read_b64_tr_b16 v[116:117], v9 offset:16384
  ds_read_b64_tr_b16 v[118:119], v9 offset:17664
  v_mfma_f32_16x16x32_bf16 v[44:47], v[136:139], v[52:55], v[44:47]
  ds_read_b128 v[84:87], v7 offset:0
  v_mfma_f32_16x16x32_bf16 v[32:35], v[140:143], v[92:95], v[32:35]
  ds_read_b128 v[88:91], v7 offset:2048
  ds_read_b64_tr_b16 v[120:121], v8 offset:21504
  v_mfma_f32_16x16x32_bf16 v[36:39], v[140:143], v[96:99], v[36:39]
  ds_read_b64_tr_b16 v[122:123], v8 offset:22784
  v_mfma_f32_16x16x32_bf16 v[48:51], v[140:143], v[52:55], v[48:51]
  ds_read_b64_tr_b16 v[124:125], v8 offset:21536
  ds_read_b64_tr_b16 v[126:127], v8 offset:22816
  v_mfma_f32_16x16x32_bf16 v[16:19], v[144:147], v[100:103], v[16:19]
  ds_read_b64_tr_b16 v[128:129], v9 offset:21504
  v_mfma_f32_16x16x32_bf16 v[20:23], v[144:147], v[104:107], v[20:23]
  ds_read_b64_tr_b16 v[130:131], v9 offset:22784
  v_mfma_f32_16x16x32_bf16 v[40:43], v[144:147], v[52:55], v[40:43]
  s_mul_i32 s58, s72, 1728
  s_add_u32 m0, s89, 16384
  s_nop 0
  buffer_load_dwordx4 v4, s[8:11], s58 offen  lds
  v_mfma_f32_16x16x32_bf16 v[24:27], v[148:151], v[100:103], v[24:27]
  v_mfma_f32_16x16x32_bf16 v[28:31], v[148:151], v[104:107], v[28:31]
  s_add_u32 m0, s89, 20480
  s_nop 0
  buffer_load_dwordx4 v156, s[8:11], s58 offen  lds
  v_mfma_f32_16x16x32_bf16 v[44:47], v[148:151], v[52:55], v[44:47]
  v_mfma_f32_16x16x32_bf16 v[32:35], v[152:155], v[100:103], v[32:35]
  s_add_u32 m0, s89, 24576
  s_mov_b64 exec, s[82:83]
  buffer_load_dwordx4 v157, s[8:11], s58 offen  lds
  s_mov_b64 exec, -1
  v_mfma_f32_16x16x32_bf16 v[36:39], v[152:155], v[104:107], v[36:39]
  v_mfma_f32_16x16x32_bf16 v[48:51], v[152:155], v[52:55], v[48:51]
  s_cmp_eq_u32 s48, 0
  s_cbranch_scc0 L_pc_4
  s_and_b32 s57, s2, 3
  s_lshl_b32 s57, s57, 6
  v_mov_b32 v12, s57
  v_mov_b32 v13, 1
  s_mov_b64 exec, 1
  buffer_atomic_add v13, v12, s[40:43], 0 offen sc1
  s_mov_b64 exec, -1
L_pc_4:
  s_waitcnt lgkmcnt(0)
  s_waitcnt vmcnt(3)
  s_barrier
  v_add_u32 v6, 26624, v6
  v_add_u32 v7, 26624, v7
  v_add_u32 v8, 26624, v8
  v_add_u32 v9, 26624, v9
  v_cndmask_b32_e64 v116, v116, v52, s[90:91]
  v_cndmask_b32_e64 v117, v117, v52, s[90:91]
  v_cndmask_b32_e64 v118, v118, v52, s[90:91]
  v_cndmask_b32_e64 v119, v119, v52, s[90:91]
  v_cndmask_b32_e64 v128, v128, v52, s[90:91]
  v_cndmask_b32_e64 v129, v129, v52, s[90:91]
  v_cndmask_b32_e64 v130, v130, v52, s[90:91]
  v_cndmask_b32_e64 v131, v131, v52, s[90:91]
  v_mfma_f32_16x16x32_bf16 v[16:19], v[108:111], v[76:79], v[16:19]
  ds_read_b128 v[92:95], v6 offset:0
  ds_read_b128 v[96:99], v6 offset:2048
  v_mfma_f32_16x16x32_bf16 v[20:23], v[108:111], v[80:83], v[20:23]
  ds_read_b64_tr_b16 v[132:133], v8 offset:16384
  v_mfma_f32_16x16x32_bf16 v[40:43], v[108:111], v[52:55], v[40:43]
  ds_read_b64_tr_b16 v[134:135], v8 offset:17664
  ds_read_b64_tr_b16 v[136:137], v8 offset:16416
  v_mfma_f32_16x16x32_bf16 v[24:27], v[112:115], v[76:79], v[24:27]
  ds_read_b64_tr_b16 v[138:139], v8 offset:17696
  v_mfma_f32_16x16x32_bf16 v[28:31], v[112:115], v[80:83], v[28:31]
  ds_read_b64_tr_b16 v[140:141], v9 offset:16384
  ds_read_b64_tr_b16 v[142:143], v9 offset:17664
  v_mfma_f32_16x16x32_bf16 v[44:47], v[112:115], v[52:55], v[44:47]
  ds_read_b128 v[100:103], v7 offset:0
  v_mfma_f32_16x16x32_bf16 v[32:35], v[116:119], v[76:79], v[32:35]
  ds_read_b128 v[104:107], v7 offset:2048
  ds_read_b64_tr_b16 v[144:145], v8 offset:21504
  v_mfma_f32_16x16x32_bf16 v[36:39], v[116:119], v[80:83], v[36:39]
  ds_read_b64_tr_b16 v[146:147], v8 offset:22784
  v_mfma_f32_16x16x32_bf16 v[48:51], v[116:119], v[52:55], v[48:51]
  ds_read_b64_tr_b16 v[148:149], v8 offset:21536
  ds_read_b64_tr_b16 v[150:151], v8 offset:22816
  v_mfma_f32_16x16x32_bf16 v[16:19], v[120:123], v[84:87], v[16:19]
  ds_read_b64_tr_b16 v[152:153], v9 offset:21504
  v_mfma_f32_16x16x32_bf16 v[20:23], v[120:123], v[88:91], v[20:23]
  ds_read_b64_tr_b16 v[154:155], v9 offset:22784
  v_mfma_f32_16x16x32_bf16 v[40:43], v[120:123], v[52:55], v[40:43]
  v_mfma_f32_16x16x32_bf16 v[24:27], v[124:127], v[84:87], v[24:27]
  v_mfma_f32_16x16x32_bf16 v[28:31], v[124:127], v[88:91], v[28:31]
  v_mfma_f32_16x16x32_bf16 v[44:47], v[124:127], v[52:55], v[44:47]
  v_mfma_f32_16x16x32_bf16 v[32:35], v[128:131], v[84:87], v[32:35]
  v_mfma_f32_16x16x32_bf16 v[36:39], v[128:131], v[88:91], v[36:39]
  v_mfma_f32_16x16x32_bf16 v[48:51], v[128:131], v[52:55], v[48:51]
  s_waitcnt lgkmcnt(0)
  s_waitcnt vmcnt(0)
  s_barrier
  v_add_u32 v6, 4294887424, v6
  v_add_u32 v7, 4294887424, v7
  v_add_u32 v8, 4294887424, v8
  v_add_u32 v9, 4294887424, v9
  v_cndmask_b32_e64 v140, v140, v52, s[90:91]
  v_cndmask_b32_e64 v141, v141, v52, s[90:91]
  v_cndmask_b32_e64 v142, v142, v52, s[90:91]
  v_cndmask_b32_e64 v143, v143, v52, s[90:91]
  v_cndmask_b32_e64 v152, v152, v52, s[90:91]
  v_cndmask_b32_e64 v153, v153, v52, s[90:91]
  v_cndmask_b32_e64 v154, v154, v52, s[90:91]
  v_cndmask_b32_e64 v155, v155, v52, s[90:91]
  v_mfma_f32_16x16x32_bf16 v[16:19], v[132:135], v[92:95], v[16:19]
  ds_read_b128 v[76:79], v6 offset:0
  ds_read_b128 v[80:83], v6 offset:2048
  v_mfma_f32_16x16x32_bf16 v[20:23], v[132:135], v[96:99], v[20:23]
  ds_read_b64_tr_b16 v[108:109], v8 offset:16384
  v_mfma_f32_16x16x32_bf16 v[40:43], v[132:135], v[52:55], v[40:43]
  ds_read_b64_tr_b16 v[110:111], v8 offset:17664
  ds_read_b64_tr_b16 v[112:113], v8 offset:16416
  v_mfma_f32_16x16x32_bf16 v[24:27], v[136:139], v[92:95], v[24:27]
  ds_read_b64_tr_b16 v[114:115], v8 offset:17696
  v_mfma_f32_16x16x32_bf16 v[28:31], v[136:139], v[96:99], v[28:31]
  ds_read_b64_tr_b16 v[116:117], v9 offset:16384
  ds_read_b64_tr_b16 v[118:119], v9 offset:17664
  v_mfma_f32_16x16x32_bf16 v[44:47], v[136:139], v[52:55], v[44:47]
  ds_read_b128 v[84:87], v7 offset:0
  v_mfma_f32_16x16x32_bf16 v[32:35], v[140:143], v[92:95], v[32:35]
  ds_read_b128 v[88:91], v7 offset:2048
  ds_read_b64_tr_b16 v[120:121], v8 offset:21504
  v_mfma_f32_16x16x32_bf16 v[36:39], v[140:143], v[96:99], v[36:39]
  ds_read_b64_tr_b16 v[122:123], v8 offset:22784
  v_mfma_f32_16x16x32_bf16 v[48:51], v[140:143], v[52:55], v[48:51]
  ds_read_b64_tr_b16 v[124:125], v8 offset:21536
  ds_read_b64_tr_b16 v[126:127], v8 offset:22816
  v_mfma_f32_16x16x32_bf16 v[16:19], v[144:147], v[100:103], v[16:19]
  ds_read_b64_tr_b16 v[128:129], v9 offset:21504
  v_mfma_f32_16x16x32_bf16 v[20:23], v[144:147], v[104:107], v[20:23]
  ds_read_b64_tr_b16 v[130:131], v9 offset:22784
  v_mfma_f32_16x16x32_bf16 v[40:43], v[144:147], v[52:55], v[40:43]
  v_mfma_f32_16x16x32_bf16 v[24:27], v[148:151], v[100:103], v[24:27]
  v_mfma_f32_16x16x32_bf16 v[28:31], v[148:151], v[104:107], v[28:31]
  v_mfma_f32_16x16x32_bf16 v[44:47], v[148:151], v[52:55], v[44:47]
  v_mfma_f32_16x16x32_bf16 v[32:35], v[152:155], v[100:103], v[32:35]
  v_mfma_f32_16x16x32_bf16 v[36:39], v[152:155], v[104:107], v[36:39]
  v_mfma_f32_16x16x32_bf16 v[48:51], v[152:155], v[52:55], v[48:51]
  s_waitcnt lgkmcnt(0)
  v_cndmask_b32_e64 v116, v116, v52, s[90:91]
  v_cndmask_b32_e64 v117, v117, v52, s[90:91]
  v_cndmask_b32_e64 v118, v118, v52, s[90:91]
  v_cndmask_b32_e64 v119, v119, v52, s[90:91]
  v_cndmask_b32_e64 v128, v128, v52, s[90:91]
  v_cndmask_b32_e64 v129, v129, v52, s[90:91]
  v_cndmask_b32_e64 v130, v130, v52, s[90:91]
  v_cndmask_b32_e64 v131, v131, v52, s[90:91]
  v_mfma_f32_16x16x32_bf16 v[16:19], v[108:111], v[76:79], v[16:19]
  v_mfma_f32_16x16x32_bf16 v[20:23], v[108:111], v[80:83], v[20:23]
  v_mfma_f32_16x16x32_bf16 v[40:43], v[108:111], v[52:55], v[40:43]
  v_mfma_f32_16x16x32_bf16 v[24:27], v[112:115], v[76:79], v[24:27]
  v_mfma_f32_16x16x32_bf16 v[28:31], v[112:115], v[80:83], v[28:31]
  v_mfma_f32_16x16x32_bf16 v[44:47], v[112:115], v[52:55], v[44:47]
  v_mfma_f32_16x16x32_bf16 v[32:35], v[116:119], v[76:79], v[32:35]
  v_mfma_f32_16x16x32_bf16 v[36:39], v[116:119], v[80:83], v[36:39]
  v_mfma_f32_16x16x32_bf16 v[48:51], v[116:119], v[52:55], v[48:51]
  v_mfma_f32_16x16x32_bf16 v[16:19], v[120:123], v[84:87], v[16:19]
  v_mfma_f32_16x16x32_bf16 v[20:23], v[120:123], v[88:91], v[20:23]
  v_mfma_f32_16x16x32_bf16 v[40:43], v[120:123], v[52:55], v[40:43]
  v_mfma_f32_16x16x32_bf16 v[24:27], v[124:127], v[84:87], v[24:27]
  v_mfma_f32_16x16x32_bf16 v[28:31], v[124:127], v[88:91], v[28:31]
  v_mfma_f32_16x16x32_bf16 v[44:47], v[124:127], v[52:55], v[44:47]
  v_mfma_f32_16x16x32_bf16 v[32:35], v[128:131], v[84:87], v[32:35]
  v_mfma_f32_16x16x32_bf16 v[36:39], v[128:131], v[88:91], v[36:39]
  v_mfma_f32_16x16x32_bf16 v[48:51], v[128:131], v[52:55], v[48:51]
  s_lshl_b32 s57, s49, 5
  v_add_u32 v12, s57, v10
  v_lshlrev_b32 v12, 3, v12
  v_add_u32 v12, 159744, v12
  s_mov_b32 exec_lo, 0
  s_mov_b32 exec_hi, 0xffff
  ds_write_b32 v12, v32 offset:0
  ds_write_b32 v12, v36 offset:128
  s_mov_b64 exec, -1
  s_waitcnt lgkmcnt(0)
  s_barrier
  ds_read_b64 v[76:77], v12 offset:0
  ds_read_b64 v[78:79], v12 offset:128
  s_waitcnt lgkmcnt(0)
  v_mul_f32 v76, 0x3ae38e39, v76
  v_mul_f32 v77, 0x3ae38e39, v77
  v_fma_f32 v77, -v76, v76, v77
  v_max_f32 v77, 0, v77
  v_add_f32 v77, 0x3727c5ac, v77
  v_rsq_f32 v92, v77
  s_nop 0
  v_mul_f32 v93, v76, v92
  v_sub_f32 v93, 0, v93
  v_mul_f32 v78, 0x3ae38e39, v78
  v_mul_f32 v79, 0x3ae38e39, v79
  v_fma_f32 v79, -v78, v78, v79
  v_max_f32 v79, 0, v79
  v_add_f32 v79, 0x3727c5ac, v79
  v_rsq_f32 v94, v79
  s_nop 0
  v_mul_f32 v95, v78, v94
  v_sub_f32 v95, 0, v95
  v_mov_b32 v14, v93
  v_pk_mul_f32 v[108:109], v[40:41], v[14:15] op_sel_hi:[1,0]
  v_pk_mul_f32 v[110:111], v[42:43], v[14:15] op_sel_hi:[1,0]
  v_pk_fma_f32 v[16:17], v[16:17], v[92:93], v[108:109] op_sel_hi:[1,0,1]
  v_pk_fma_f32 v[18:19], v[18:19], v[92:93], v[110:111] op_sel_hi:[1,0,1]
  v_cvt_pk_bf16_f32 v96, v16, v17
  v_cvt_pk_bf16_f32 v97, v18, v19
  v_pk_mul_f32 v[108:109], v[44:45], v[14:15] op_sel_hi:[1,0]
  v_pk_mul_f32 v[110:111], v[46:47], v[14:15] op_sel_hi:[1,0]
  v_pk_fma_f32 v[24:25], v[24:25], v[92:93], v[108:109] op_sel_hi:[1,0,1]
  v_pk_fma_f32 v[26:27], v[26:27], v[92:93], v[110:111] op_sel_hi:[1,0,1]
  v_cvt_pk_bf16_f32 v98, v24, v25
  v_cvt_pk_bf16_f32 v99, v26, v27
  v_pk_mul_f32 v[108:109], v[48:49], v[14:15] op_sel_hi:[1,0]
  v_pk_mul_f32 v[110:111], v[50:51], v[14:15] op_sel_hi:[1,0]
  v_pk_fma_f32 v[32:33], v[32:33], v[92:93], v[108:109] op_sel_hi:[1,0,1]
  v_pk_fma_f32 v[34:35], v[34:35], v[92:93], v[110:111] op_sel_hi:[1,0,1]
  v_cvt_pk_bf16_f32 v100, v32, v33
  v_cvt_pk_bf16_f32 v101, v34, v35
  v_mov_b32 v14, v95
  v_pk_mul_f32 v[108:109], v[40:41], v[14:15] op_sel_hi:[1,0]
  v_pk_mul_f32 v[110:111], v[42:43], v[14:15] op_sel_hi:[1,0]
  v_pk_fma_f32 v[20:21], v[20:21], v[94:95], v[108:109] op_sel_hi:[1,0,1]
  v_pk_fma_f32 v[22:23], v[22:23], v[94:95], v[110:111] op_sel_hi:[1,0,1]
  v_cvt_pk_bf16_f32 v102, v20, v21
  v_cvt_pk_bf16_f32 v103, v22, v23
  v_pk_mul_f32 v[108:109], v[44:45], v[14:15] op_sel_hi:[1,0]
  v_pk_mul_f32 v[110:111], v[46:47], v[14:15] op_sel_hi:[1,0]
  v_pk_fma_f32 v[28:29], v[28:29], v[94:95], v[108:109] op_sel_hi:[1,0,1]
  v_pk_fma_f32 v[30:31], v[30:31], v[94:95], v[110:111] op_sel_hi:[1,0,1]
  v_cvt_pk_bf16_f32 v104, v28, v29
  v_cvt_pk_bf16_f32 v105, v30, v31
  v_pk_mul_f32 v[108:109], v[48:49], v[14:15] op_sel_hi:[1,0]
  v_pk_mul_f32 v[110:111], v[50:51], v[14:15] op_sel_hi:[1,0]
  v_pk_fma_f32 v[36:37], v[36:37], v[94:95], v[108:109] op_sel_hi:[1,0,1]
  v_pk_fma_f32 v[38:39], v[38:39], v[94:95], v[110:111] op_sel_hi:[1,0,1]
  v_cvt_pk_bf16_f32 v106, v36, v37
  v_cvt_pk_bf16_f32 v107, v38, v39
  s_lshl_b32 s57, s49, 5
  v_add_u32 v12, s57, v10
  v_mul_u32_u24 v12, 80, v12
  v_cmp_eq_u32 vcc, 2, v11
  v_mov_b32 v13, 32
  v_mov_b32 v14, 72
  v_cndmask_b32 v13, v13, v14, vcc
  v_add_u32 v12, v12, v13
  v_mov_b32 v14, 0x3f80
  v_mov_b32 v15, 0
  v_cndmask_b32 v108, v100, v14, vcc
  v_cndmask_b32 v109, v101, v15, vcc
  v_cndmask_b32 v110, v106, v14, vcc
  v_cndmask_b32 v111, v107, v15, vcc
  s_mov_b32 exec_lo, 0xffff0000
  s_mov_b32 exec_hi, 0x0000ffff
  ds_write_b64 v12, v[108:109] offset:0
  ds_write_b64 v12, v[110:111] offset:1280
  s_mov_b64 exec, -1
  v_mfma_f32_16x16x32_bf16 v[16:19], v[56:59], v[96:99], 0
  v_mfma_f32_16x16x32_bf16 v[20:23], v[56:59], v[102:105], 0
  v_mfma_f32_16x16x32_bf16 v[24:27], v[62:65], v[96:99], 0
  v_mfma_f32_16x16x32_bf16 v[28:31], v[62:65], v[102:105], 0
  v_mfma_f32_16x16x32_bf16 v[32:35], v[68:71], v[96:99], 0
  v_mfma_f32_16x16x32_bf16 v[36:39], v[68:71], v[102:105], 0
  s_nop 0
  v_mfma_f32_16x16x16_bf16 v[16:19], v[60:61], v[100:101], v[16:19]
  v_mfma_f32_16x16x16_bf16 v[20:23], v[60:61], v[106:107], v[20:23]
  v_mfma_f32_16x16x16_bf16 v[24:27], v[66:67], v[100:101], v[24:27]
  v_mfma_f32_16x16x16_bf16 v[28:31], v[66:67], v[106:107], v[28:31]
  v_mfma_f32_16x16x16_bf16 v[32:35], v[72:73], v[100:101], v[32:35]
  v_mfma_f32_16x16x16_bf16 v[36:39], v[72:73], v[106:107], v[36:39]
  s_nop 3
  v_permlane16_swap_b32 v16, v20
  v_permlane16_swap_b32 v17, v21
  v_permlane16_swap_b32 v18, v22
  v_permlane16_swap_b32 v19, v23
  v_permlane16_swap_b32 v24, v28
  v_permlane16_swap_b32 v25, v29
  v_permlane16_swap_b32 v26, v30
  v_permlane16_swap_b32 v27, v31
  v_permlane16_swap_b32 v32, v36
  v_permlane16_swap_b32 v33, v37
  v_max3_f32 v112, v16, v17, v18
  v_min3_f32 v114, v16, v17, v18
  v_max3_f32 v112, v112, v19, v20
  v_min3_f32 v114, v114, v19, v20
  v_max3_f32 v112, v112, v21, v22
  v_min3_f32 v114, v114, v21, v22
  v_max3_f32 v112, v112, v23, v24
  v_min3_f32 v114, v114, v23, v24
  v_max3_f32 v112, v112, v25, v26
  v_min3_f32 v114, v114, v25, v26
  v_max3_f32 v112, v112, v27, v28
  v_min3_f32 v114, v114, v27, v28
  v_max3_f32 v112, v112, v29, v30
  v_min3_f32 v114, v114, v29, v30
  v_max3_f32 v112, v112, v31, v32
  v_min3_f32 v114, v114, v31, v32
  v_max_f32 v112, v112, v33
  v_min_f32 v114, v114, v33
  v_mul_f32 v112, s92, v112
  v_mul_f32 v114, s92, v114
  v_mov_b32 v116, s92
  v_pk_fma_f32 v[76:77], v[16:17], v[116:117], v[112:113] op_sel_hi:[1,0,0] neg_lo:[0,0,1] neg_hi:[0,0,1]
  v_pk_fma_f32 v[94:95], v[16:17], v[116:117], v[114:115] op_sel_hi:[1,0,0] neg_lo:[1,0,0] neg_hi:[1,0,0]
  v_pk_fma_f32 v[78:79], v[18:19], v[116:117], v[112:113] op_sel_hi:[1,0,0] neg_lo:[0,0,1] neg_hi:[0,0,1]
  v_pk_fma_f32 v[96:97], v[18:19], v[116:117], v[114:115] op_sel_hi:[1,0,0] neg_lo:[1,0,0] neg_hi:[1,0,0]
  v_pk_fma_f32 v[80:81], v[20:21], v[116:117], v[112:113] op_sel_hi:[1,0,0] neg_lo:[0,0,1] neg_hi:[0,0,1]
  v_pk_fma_f32 v[98:99], v[20:21], v[116:117], v[114:115] op_sel_hi:[1,0,0] neg_lo:[1,0,0] neg_hi:[1,0,0]
  v_pk_fma_f32 v[82:83], v[22:23], v[116:117], v[112:113] op_sel_hi:[1,0,0] neg_lo:[0,0,1] neg_hi:[0,0,1]
  v_pk_fma_f32 v[100:101], v[22:23], v[116:117], v[114:115] op_sel_hi:[1,0,0] neg_lo:[1,0,0] neg_hi:[1,0,0]
  v_pk_fma_f32 v[84:85], v[24:25], v[116:117], v[112:113] op_sel_hi:[1,0,0] neg_lo:[0,0,1] neg_hi:[0,0,1]
  v_pk_fma_f32 v[102:103], v[24:25], v[116:117], v[114:115] op_sel_hi:[1,0,0] neg_lo:[1,0,0] neg_hi:[1,0,0]
  v_pk_fma_f32 v[86:87], v[26:27], v[116:117], v[112:113] op_sel_hi:[1,0,0] neg_lo:[0,0,1] neg_hi:[0,0,1]
  v_pk_fma_f32 v[104:105], v[26:27], v[116:117], v[114:115] op_sel_hi:[1,0,0] neg_lo:[1,0,0] neg_hi:[1,0,0]
  v_pk_fma_f32 v[88:89], v[28:29], v[116:117], v[112:113] op_sel_hi:[1,0,0] neg_lo:[0,0,1] neg_hi:[0,0,1]
  v_pk_fma_f32 v[106:107], v[28:29], v[116:117], v[114:115] op_sel_hi:[1,0,0] neg_lo:[1,0,0] neg_hi:[1,0,0]
  v_pk_fma_f32 v[90:91], v[30:31], v[116:117], v[112:113] op_sel_hi:[1,0,0] neg_lo:[0,0,1] neg_hi:[0,0,1]
  v_pk_fma_f32 v[108:109], v[30:31], v[116:117], v[114:115] op_sel_hi:[1,0,0] neg_lo:[1,0,0] neg_hi:[1,0,0]
  v_pk_fma_f32 v[92:93], v[32:33], v[116:117], v[112:113] op_sel_hi:[1,0,0] neg_lo:[0,0,1] neg_hi:[0,0,1]
  v_pk_fma_f32 v[110:111], v[32:33], v[116:117], v[114:115] op_sel_hi:[1,0,0] neg_lo:[1,0,0] neg_hi:[1,0,0]
  v_exp_f32 v76, v76
  v_exp_f32 v94, v94
  v_exp_f32 v77, v77
  v_exp_f32 v95, v95
  v_exp_f32 v78, v78
  v_exp_f32 v96, v96
  v_exp_f32 v79, v79
  v_exp_f32 v97, v97
  v_exp_f32 v80, v80
  v_exp_f32 v98, v98
  v_exp_f32 v81, v81
  v_exp_f32 v99, v99
  v_exp_f32 v82, v82
  v_exp_f32 v100, v100
  v_exp_f32 v83, v83
  v_exp_f32 v101, v101
  v_exp_f32 v84, v84
  v_exp_f32 v102, v102
  v_exp_f32 v85, v85
  v_exp_f32 v103, v103
  v_exp_f32 v86, v86
  v_exp_f32 v104, v104
  v_exp_f32 v87, v87
  v_exp_f32 v105, v105
  v_exp_f32 v88, v88
  v_exp_f32 v106, v106
  v_exp_f32 v89, v89
  v_exp_f32 v107, v107
  v_exp_f32 v90, v90
  v_exp_f32 v108, v108
  v_exp_f32 v91, v91
  v_exp_f32 v109, v109
  v_exp_f32 v92, v92
  v_exp_f32 v110, v110
  v_exp_f32 v93, v93
  v_exp_f32 v111, v111
  v_pk_add_f32 v[112:113], v[76:77], v[78:79]
  v_pk_add_f32 v[114:115], v[94:95], v[96:97]
  v_pk_add_f32 v[116:117], v[80:81], v[82:83]
  v_pk_add_f32 v[118:119], v[98:99], v[100:101]
  v_pk_add_f32 v[112:113], v[112:113], v[84:85]
  v_pk_add_f32 v[114:115], v[114:115], v[102:103]
  v_pk_add_f32 v[116:117], v[116:117], v[86:87]
  v_pk_add_f32 v[118:119], v[118:119], v[104:105]
  v_pk_add_f32 v[112:113], v[112:113], v[88:89]
  v_pk_add_f32 v[114:115], v[114:115], v[106:107]
  v_pk_add_f32 v[116:117], v[116:117], v[90:91]
  v_pk_add_f32 v[118:119], v[118:119], v[108:109]
  v_pk_add_f32 v[112:113], v[112:113], v[92:93]
  v_pk_add_f32 v[114:115], v[114:115], v[110:111]
  v_pk_add_f32 v[112:113], v[112:113], v[116:117]
  v_pk_add_f32 v[114:115], v[114:115], v[118:119]
  v_add_f32 v112, v112, v113
  v_add_f32 v114, v114, v115
  v_rcp_f32 v112, v112
  v_rcp_f32 v114, v114
  v_pk_mul_f32 v[76:77], v[76:77], v[112:113] op_sel_hi:[1,0]
  v_pk_mul_f32 v[94:95], v[94:95], v[114:115] op_sel_hi:[1,0]
  v_pk_mul_f32 v[78:79], v[78:79], v[112:113] op_sel_hi:[1,0]
  v_pk_mul_f32 v[96:97], v[96:97], v[114:115] op_sel_hi:[1,0]
  v_pk_mul_f32 v[80:81], v[80:81], v[112:113] op_sel_hi:[1,0]
  v_pk_mul_f32 v[98:99], v[98:99], v[114:115] op_sel_hi:[1,0]
  v_pk_mul_f32 v[82:83], v[82:83], v[112:113] op_sel_hi:[1,0]
  v_pk_mul_f32 v[100:101], v[100:101], v[114:115] op_sel_hi:[1,0]
  v_pk_mul_f32 v[84:85], v[84:85], v[112:113] op_sel_hi:[1,0]
  v_pk_mul_f32 v[102:103], v[102:103], v[114:115] op_sel_hi:[1,0]
  v_pk_mul_f32 v[86:87], v[86:87], v[112:113] op_sel_hi:[1,0]
  v_pk_mul_f32 v[104:105], v[104:105], v[114:115] op_sel_hi:[1,0]
  v_pk_mul_f32 v[88:89], v[88:89], v[112:113] op_sel_hi:[1,0]
  v_pk_mul_f32 v[106:107], v[106:107], v[114:115] op_sel_hi:[1,0]
  v_pk_mul_f32 v[90:91], v[90:91], v[112:113] op_sel_hi:[1,0]
  v_pk_mul_f32 v[108:109], v[108:109], v[114:115] op_sel_hi:[1,0]
  v_pk_mul_f32 v[92:93], v[92:93], v[112:113] op_sel_hi:[1,0]
  v_pk_mul_f32 v[110:111], v[110:111], v[114:115] op_sel_hi:[1,0]
  v_cvt_pk_bf16_f32 v16, v76, v77
  v_cvt_pk_bf16_f32 v17, v78, v79
  v_cvt_pk_bf16_f32 v18, v80, v81
  v_cvt_pk_bf16_f32 v19, v82, v83
  v_cvt_pk_bf16_f32 v20, v84, v85
  v_cvt_pk_bf16_f32 v21, v86, v87
  v_cvt_pk_bf16_f32 v22, v88, v89
  v_cvt_pk_bf16_f32 v23, v90, v91
  v_cvt_pk_bf16_f32 v24, v92, v93
  v_cvt_pk_bf16_f32 v25, v94, v95
  v_cvt_pk_bf16_f32 v26, v96, v97
  v_cvt_pk_bf16_f32 v27, v98, v99
  v_cvt_pk_bf16_f32 v28, v100, v101
  v_cvt_pk_bf16_f32 v29, v102, v103
  v_cvt_pk_bf16_f32 v30, v104, v105
  v_cvt_pk_bf16_f32 v31, v106, v107
  v_cvt_pk_bf16_f32 v32, v108, v109
  v_cvt_pk_bf16_f32 v33, v110, v111
  v_and_b32 v12, 1, v11
  v_lshlrev_b32 v12, 4, v12
  v_add_u32 v12, v12, v10
  s_lshl_b32 s57, s49, 5
  v_add_u32 v12, s57, v12
  v_mul_u32_u24 v12, 160, v12
  v_lshrrev_b32 v13, 1, v11
  v_mul_u32_u24 v13, 80, v13
  v_add_u32 v12, v12, v13
  v_add_u32 v12, 77824, v12
  ds_write_b128 v12, v[16:19] offset:0
  ds_write_b128 v12, v[20:23] offset:16
  ds_write_b128 v12, v[24:27] offset:32
  ds_write_b128 v12, v[28:31] offset:48
  ds_write_b64 v12, v[32:33] offset:64
  s_waitcnt lgkmcnt(0)
  v_mov_b32 v12, 163808
  v_mov_b32 v13, 1
  s_mov_b64 exec, 1
  ds_add_u32 v12, v13
  s_mov_b64 exec, -1
  v_lshlrev_b32 v158, 6, v1
  v_cmp_gt_u32 vcc, 4, v1
  v_mov_b32 v159, 0x7fffffff
  s_nop 0
  v_cndmask_b32 v158, v159, v158, vcc
  buffer_load_dword v159, v158, s[40:43], 0 offen sc1
  s_lshr_b32 s61, s49, 1
  s_and_b32 s62, s49, 1
  v_lshrrev_b32 v12, 2, v1
  v_and_b32 v13, 3, v1
  v_mul_u32_u24 v14, 160, v12
  v_lshl_add_u32 v14, v13, 3, v14
  s_mul_i32 s58, s61, 80
  s_add_u32 s58, s58, 77824
  v_add_u32 v36, s58, v14
  v_mul_u32_u24 v14, 80, v12
  s_mul_i32 s58, s61, 40
  v_lshl_add_u32 v15, v13, 3, s58
  v_cmp_eq_u32 vcc, 1, v13
  v_mov_b32 v38, 32
  v_mov_b32 v39, 72
  v_cndmask_b32 v38, v38, v39, vcc
  s_cmp_eq_u32 s62, 0
  s_cselect_b64 vcc, -1, 0
  s_nop 1
  v_cndmask_b32 v15, v38, v15, vcc
  v_add_u32 v37, v14, v15
  v_mov_b32 v12, 163808
  s_mov_b32 s93, 0
L_lw_5:
  ds_read_b32 v13, v12
  s_add_u32 s93, s93, 1
  s_waitcnt lgkmcnt(0)
  v_readfirstlane_b32 s57, v13
  s_cmp_gt_u32 s93, 40000
  s_cbranch_scc1 L_lwd_6
  s_cmp_lt_u32 s57, 8
  s_cbranch_scc1 L_lw_5
L_lwd_6:
  ds_read_b64_tr_b16 v[124:125], v37 offset:0
  ds_read_b64_tr_b16 v[126:127], v37 offset:1280
  ds_read_b64_tr_b16 v[76:77], v36 offset:0
  ds_read_b64_tr_b16 v[78:79], v36 offset:2560
  ds_read_b64_tr_b16 v[80:81], v36 offset:32
  ds_read_b64_tr_b16 v[82:83], v36 offset:2592
  ds_read_b64_tr_b16 v[84:85], v36 offset:64
  ds_read_b64_tr_b16 v[86:87], v36 offset:2624
  ds_read_b64_tr_b16 v[128:129], v37 offset:2560
  ds_read_b64_tr_b16 v[130:131], v37 offset:3840
  ds_read_b64_tr_b16 v[88:89], v36 offset:5120
  ds_read_b64_tr_b16 v[90:91], v36 offset:7680
  ds_read_b64_tr_b16 v[92:93], v36 offset:5152
  ds_read_b64_tr_b16 v[94:95], v36 offset:7712
  ds_read_b64_tr_b16 v[96:97], v36 offset:5184
  ds_read_b64_tr_b16 v[98:99], v36 offset:7744
  ds_read_b64_tr_b16 v[132:133], v37 offset:5120
  ds_read_b64_tr_b16 v[134:135], v37 offset:6400
  ds_read_b64_tr_b16 v[100:101], v36 offset:10240
  ds_read_b64_tr_b16 v[102:103], v36 offset:12800
  ds_read_b64_tr_b16 v[104:105], v36 offset:10272
  ds_read_b64_tr_b16 v[106:107], v36 offset:12832
  ds_read_b64_tr_b16 v[108:109], v36 offset:10304
  ds_read_b64_tr_b16 v[110:111], v36 offset:12864
  ds_read_b64_tr_b16 v[136:137], v37 offset:7680
  ds_read_b64_tr_b16 v[138:139], v37 offset:8960
  ds_read_b64_tr_b16 v[112:113], v36 offset:15360
  ds_read_b64_tr_b16 v[114:115], v36 offset:17920
  ds_read_b64_tr_b16 v[116:117], v36 offset:15392
  ds_read_b64_tr_b16 v[118:119], v36 offset:17952
  ds_read_b64_tr_b16 v[120:121], v36 offset:15424
  ds_read_b64_tr_b16 v[122:123], v36 offset:17984
  s_waitcnt lgkmcnt(15)
  v_mfma_f32_16x16x32_bf16 v[16:19], v[76:79], v[124:127], 0
  v_mfma_f32_16x16x32_bf16 v[20:23], v[80:83], v[124:127], 0
  v_mfma_f32_16x16x32_bf16 v[24:27], v[84:87], v[124:127], 0
  s_waitcnt lgkmcnt(15)
  v_mfma_f32_16x16x32_bf16 v[16:19], v[88:91], v[128:131], v[16:19]
  v_mfma_f32_16x16x32_bf16 v[20:23], v[92:95], v[128:131], v[20:23]
  v_mfma_f32_16x16x32_bf16 v[24:27], v[96:99], v[128:131], v[24:27]
  s_waitcnt lgkmcnt(8)
  v_mfma_f32_16x16x32_bf16 v[16:19], v[100:103], v[132:135], v[16:19]
  v_mfma_f32_16x16x32_bf16 v[20:23], v[104:107], v[132:135], v[20:23]
  v_mfma_f32_16x16x32_bf16 v[24:27], v[108:111], v[132:135], v[24:27]
  s_waitcnt lgkmcnt(0)
  v_mfma_f32_16x16x32_bf16 v[16:19], v[112:115], v[136:139], v[16:19]
  v_mfma_f32_16x16x32_bf16 v[20:23], v[116:119], v[136:139], v[20:23]
  v_mfma_f32_16x16x32_bf16 v[24:27], v[120:123], v[136:139], v[24:27]
  v_cmp_eq_u32 vcc, 0, v11
  s_mul_i32 s60, s49, 1536
  s_add_u32 s60, s60, 98304
  v_mul_u32_u24 v12, 80, v10
  v_lshl_add_u32 v12, v11, 3, v12
  v_add_u32 v36, s60, v12
  v_cvt_pk_bf16_f32 v28, v16, v17
  v_cvt_pk_bf16_f32 v29, v18, v19
  v_cvt_pk_bf16_f32 v30, v20, v21
  v_cvt_pk_bf16_f32 v31, v22, v23
  v_cvt_pk_bf16_f32 v32, v24, v25
  v_cvt_pk_bf16_f32 v33, v26, v27
  v_mov_b32 v14, 0
  v_cndmask_b32 v32, v14, v32, vcc
  v_cndmask_b32 v33, v14, v33, vcc
  ds_write_b64 v36, v[28:29]
  ds_write_b64 v36, v[30:31] offset:32
  s_mov_b32 exec_hi, 0
  ds_write_b64 v36, v[32:33] offset:64
  s_mov_b32 exec_hi, -1
  s_mov_b32 s93, 0
  s_waitcnt vmcnt(0)
  v_cmp_eq_u32 vcc, 64, v159
  s_nop 1
  s_and_b32 s57, vcc_lo, 15
  s_cmp_eq_u32 s57, 15
  s_cbranch_scc1 L_rcd_8
L_rc_7:
  buffer_load_dword v159, v158, s[40:43], 0 offen sc1
  s_add_u32 s93, s93, 1
  s_waitcnt vmcnt(0)
  v_cmp_eq_u32 vcc, 64, v159
  s_cmp_gt_u32 s93, 40000
  s_cbranch_scc1 L_rcd_8
  s_and_b32 s57, vcc_lo, 15
  s_cmp_eq_u32 s57, 15
  s_cbranch_scc0 L_rc_7
L_rcd_8:
  s_lshl_b32 s58, s51, 4
  s_add_u32 s58, s58, s50
  s_mul_i32 s58, s58, 3072
  s_add_u32 s58, s58, 0
  s_waitcnt lgkmcnt(0)
  v_lshlrev_b32 v13, 4, v1
  s_cmp_eq_u32 s62, 0
  s_cbranch_scc0 L_sh_9
  s_mul_i32 s59, s61, 1680
  s_add_u32 s58, s58, s59
  v_add_u32 v12, s60, v13
  ds_read_b128 v[16:19], v12
  ds_read_b128 v[20:23], v12 offset:1024
  s_waitcnt lgkmcnt(1)
  buffer_store_dwordx4 v[16:19], v13, s[12:15], s58 offen sc1
  s_waitcnt lgkmcnt(0)
  s_mov_b32 exec_lo, 0xffff
  s_mov_b32 exec_hi, 0
  buffer_store_dwordx4 v[20:23], v13, s[12:15], s58 offen offset:1024 sc1
  s_mov_b64 exec, -1
  s_branch L_pd_10
L_sh_9:
  s_mul_i32 s59, s61, 160
  v_add_u32 v14, s59, v13
  v_add_u32 v15, 160, v13
  v_cmp_gt_u32 vcc, 10, v1
  s_nop 1
  v_cndmask_b32 v14, v15, v14, vcc
  v_add_u32 v14, s60, v14
  ds_read_b128 v[16:19], v14
  s_mul_i32 s59, s61, 240
  s_add_u32 s59, s59, 1280
  v_add_u32 v14, s59, v13
  s_mul_i32 s59, s61, 1520
  s_add_u32 s59, s59, 1280
  v_add_u32 v15, s59, v13
  v_cndmask_b32 v14, v15, v14, vcc
  v_cmp_gt_u32 vcc, 15, v1
  s_waitcnt lgkmcnt(0)
  v_mov_b32 v20, 0
  v_cndmask_b32 v16, v20, v16, vcc
  v_cndmask_b32 v17, v20, v17, vcc
  v_cndmask_b32 v18, v20, v18, vcc
  v_cndmask_b32 v19, v20, v19, vcc
  s_lshl_b32 s59, s61, 1
  s_add_u32 s59, s59, 15
  v_cmp_gt_u32 vcc, s59, v1
  s_nop 0
  s_and_saveexec_b64 s[94:95], vcc
  buffer_store_dwordx4 v[16:19], v14, s[12:15], s58 offen sc1
  s_mov_b64 exec, s[94:95]
L_pd_10:
  s_lshl_b32 s57, s49, 6
  s_add_u32 s57, s57, 0
  v_add_u32 v12, s57, v1
  v_mul_u32_u24 v13, 3641, v12
  v_lshrrev_b32 v13, 16, v13
  v_mul_u32_u24 v14, 18, v13
  v_sub_u32 v14, v12, v14
  v_lshlrev_b32 v14, 4, v14
  s_mul_i32 s57, s53, 288
  v_add_u32 v14, s57, v14
  v_and_b32 v15, 0xfffffff3, v13
  v_and_b32 v12, 4, v13
  v_lshl_or_b32 v15, v12, 1, v15
  v_and_b32 v12, 8, v13
  v_lshrrev_b32 v12, 1, v12
  v_or_b32 v15, v15, v12
  v_mul_u32_u24 v15, 1152, v15
  v_add_u32 v140, v15, v14
  v_lshrrev_b32 v15, 4, v13
  v_lshlrev_b32 v15, 2, v15
  v_bfe_u32 v12, v13, 2, 1
  v_lshl_add_u32 v15, v12, 1, v15
  v_bfe_u32 v12, v13, 3, 1
  v_add_u32 v15, v15, v12
  v_mul_u32_u24 v15, 36, v15
  v_and_b32 v12, 3, v13
  v_add3_u32 v15, v15, v12, 32
  v_mul_u32_u24 v15, 1152, v15
  v_add_u32 v143, v15, v14
  s_lshl_b32 s57, s49, 6
  s_add_u32 s57, s57, 256
  v_add_u32 v12, s57, v1
  v_mul_u32_u24 v13, 3641, v12
  v_lshrrev_b32 v13, 16, v13
  v_mul_u32_u24 v14, 18, v13
  v_sub_u32 v14, v12, v14
  v_lshlrev_b32 v14, 4, v14
  s_mul_i32 s57, s53, 288
  v_add_u32 v14, s57, v14
  v_and_b32 v15, 0xfffffff3, v13
  v_and_b32 v12, 4, v13
  v_lshl_or_b32 v15, v12, 1, v15
  v_and_b32 v12, 8, v13
  v_lshrrev_b32 v12, 1, v12
  v_or_b32 v15, v15, v12
  v_mul_u32_u24 v15, 1152, v15
  v_add_u32 v141, v15, v14
  v_lshrrev_b32 v15, 4, v13
  v_lshlrev_b32 v15, 2, v15
  v_bfe_u32 v12, v13, 2, 1
  v_lshl_add_u32 v15, v12, 1, v15
  v_bfe_u32 v12, v13, 3, 1
  v_add_u32 v15, v15, v12
  v_mul_u32_u24 v15, 36, v15
  v_and_b32 v12, 3, v13
  v_add3_u32 v15, v15, v12, 32
  v_mul_u32_u24 v15, 1152, v15
  v_add_u32 v144, v15, v14
  v_add_u32 v12, 512, v1
  v_mul_u32_u24 v13, 3641, v12
  v_lshrrev_b32 v13, 16, v13
  v_mul_u32_u24 v14, 18, v13
  v_sub_u32 v14, v12, v14
  v_lshlrev_b32 v14, 4, v14
  s_mul_i32 s57, s53, 288
  v_add_u32 v14, s57, v14
  v_and_b32 v15, 0xfffffff3, v13
  v_and_b32 v12, 4, v13
  v_lshl_or_b32 v15, v12, 1, v15
  v_and_b32 v12, 8, v13
  v_lshrrev_b32 v12, 1, v12
  v_or_b32 v15, v15, v12
  v_mul_u32_u24 v15, 1152, v15
  v_add_u32 v142, v15, v14
  v_lshrrev_b32 v15, 4, v13
  v_lshlrev_b32 v15, 2, v15
  v_bfe_u32 v12, v13, 2, 1
  v_lshl_add_u32 v15, v12, 1, v15
  v_bfe_u32 v12, v13, 3, 1
  v_add_u32 v15, v15, v12
  v_mul_u32_u24 v15, 36, v15
  v_and_b32 v12, 3, v13
  v_add3_u32 v15, v15, v12, 32
  v_mul_u32_u24 v15, 1152, v15
  v_add_u32 v145, v15, v14
  v_mul_u32_u24 v12, 3072, v11
  v_lshl_add_u32 v36, v10, 4, v12
  s_mul_i32 s60, s51, 49152
  s_mul_i32 s59, s49, 768
  s_add_u32 s60, s60, s59
  s_add_u32 s60, s60, 0
  v_and_b32 v13, 1, v10
  v_cmp_eq_u32 vcc, 1, v13
  v_mov_b32 v14, 0x3f80
  v_mov_b32 v15, 0x3f800000
  v_cndmask_b32 v13, v14, v15, vcc
  v_lshrrev_b32 v14, 1, v10
  v_mov_b32 v15, 0
  v_cmp_eq_u32 vcc, 0, v14
  s_nop 1
  v_cndmask_b32 v124, v15, v13, vcc
  v_cmp_eq_u32 vcc, 1, v14
  s_nop 1
  v_cndmask_b32 v125, v15, v13, vcc
  v_cmp_eq_u32 vcc, 2, v14
  s_nop 1
  v_cndmask_b32 v126, v15, v13, vcc
  v_cmp_eq_u32 vcc, 3, v14
  s_nop 1
  v_cndmask_b32 v127, v15, v13, vcc
  s_lshl_b32 s58, s49, 10
  s_mov_b32 s57, 0
  s_add_u32 m0, s58, 13312
  s_nop 0
  buffer_load_dwordx4 v140, s[20:23], s57 offen  lds
  s_add_u32 m0, s58, 17408
  s_nop 0
  buffer_load_dwordx4 v141, s[20:23], s57 offen  lds
  s_mov_b32 s57, 41472
  s_add_u32 m0, s58, 22528
  s_nop 0
  buffer_load_dwordx4 v140, s[20:23], s57 offen  lds
  s_add_u32 m0, s58, 26624
  s_nop 0
  buffer_load_dwordx4 v141, s[20:23], s57 offen  lds
  s_mov_b32 s57, 82944
  s_add_u32 m0, s58, 31744
  s_nop 0
  buffer_load_dwordx4 v140, s[20:23], s57 offen  lds
  s_add_u32 m0, s58, 35840
  s_nop 0
  buffer_load_dwordx4 v141, s[20:23], s57 offen  lds
  s_mov_b32 s57, 124416
  s_add_u32 m0, s58, 40960
  s_nop 0
  buffer_load_dwordx4 v140, s[20:23], s57 offen  lds
  s_add_u32 m0, s58, 45056
  s_nop 0
  buffer_load_dwordx4 v141, s[20:23], s57 offen  lds
  s_mov_b32 s57, 165888
  s_add_u32 m0, s58, 50176
  s_nop 0
  buffer_load_dwordx4 v140, s[20:23], s57 offen  lds
  s_add_u32 m0, s58, 54272
  s_nop 0
  buffer_load_dwordx4 v141, s[20:23], s57 offen  lds
  s_mov_b32 s57, 207360
  s_add_u32 m0, s58, 59392
  s_nop 0
  buffer_load_dwordx4 v140, s[20:23], s57 offen  lds
  s_add_u32 m0, s58, 63488
  s_nop 0
  buffer_load_dwordx4 v141, s[20:23], s57 offen  lds
  s_mov_b32 s57, 248832
  s_add_u32 m0, s58, 68608
  s_nop 0
  buffer_load_dwordx4 v140, s[20:23], s57 offen  lds
  s_add_u32 m0, s58, 72704
  s_nop 0
  buffer_load_dwordx4 v141, s[20:23], s57 offen  lds
  s_add_u32 s59, s49, 0
  s_min_u32 s59, s59, 6
  s_mul_i32 s57, s59, 9216
  s_add_u32 m0, s57, 21504
  s_add_u32 s59, s59, 0
  s_mul_i32 s57, s59, 41472
  buffer_load_dwordx4 v142, s[20:23], s57 offen  lds
  s_add_u32 s59, s49, 4
  s_min_u32 s59, s59, 6
  s_mul_i32 s57, s59, 9216
  s_add_u32 m0, s57, 21504
  s_add_u32 s59, s59, 0
  s_mul_i32 s57, s59, 41472
  buffer_load_dwordx4 v142, s[20:23], s57 offen  lds
  s_waitcnt vmcnt(16)
  s_add_u32 s59, s60, 0
  buffer_load_dwordx4 v[76:79], v36, s[12:15], s59 offen sc1
  s_add_u32 s59, s60, 12288
  buffer_load_dwordx4 v[80:83], v36, s[12:15], s59 offen sc1
  s_add_u32 s59, s60, 24576
  buffer_load_dwordx4 v[84:87], v36, s[12:15], s59 offen sc1
  s_add_u32 s59, s60, 36864
  buffer_load_dwordx4 v[88:91], v36, s[12:15], s59 offen sc1
  s_add_u32 s59, s60, 256
  buffer_load_dwordx4 v[92:95], v36, s[12:15], s59 offen sc1
  s_add_u32 s59, s60, 12544
  buffer_load_dwordx4 v[96:99], v36, s[12:15], s59 offen sc1
  s_add_u32 s59, s60, 24832
  buffer_load_dwordx4 v[100:103], v36, s[12:15], s59 offen sc1
  s_add_u32 s59, s60, 37120
  buffer_load_dwordx4 v[104:107], v36, s[12:15], s59 offen sc1
  s_add_u32 s59, s60, 512
  buffer_load_dwordx4 v[108:111], v36, s[12:15], s59 offen sc1
  s_add_u32 s59, s60, 12800
  buffer_load_dwordx4 v[112:115], v36, s[12:15], s59 offen sc1
  s_add_u32 s59, s60, 25088
  buffer_load_dwordx4 v[116:119], v36, s[12:15], s59 offen sc1
  s_add_u32 s59, s60, 37376
  buffer_load_dwordx4 v[120:123], v36, s[12:15], s59 offen sc1
  s_waitcnt vmcnt(12)
  s_waitcnt lgkmcnt(0)
  v_mov_b32 v12, 163816
  v_mov_b32 v13, 1
  s_mov_b64 exec, 1
  ds_add_u32 v12, v13
  s_mov_b64 exec, -1
  s_waitcnt vmcnt(11)
  v_mfma_f32_16x16x32_bf16 v[128:131], v[124:127], v[76:79], 0
  s_waitcnt vmcnt(10)
  v_mfma_f32_16x16x32_bf16 v[128:131], v[124:127], v[80:83], v[128:131]
  s_waitcnt vmcnt(9)
  v_mfma_f32_16x16x32_bf16 v[128:131], v[124:127], v[84:87], v[128:131]
  s_waitcnt vmcnt(8)
  v_mfma_f32_16x16x32_bf16 v[128:131], v[124:127], v[88:91], v[128:131]
  s_waitcnt vmcnt(7)
  v_mfma_f32_16x16x32_bf16 v[132:135], v[124:127], v[92:95], 0
  s_waitcnt vmcnt(6)
  v_mfma_f32_16x16x32_bf16 v[132:135], v[124:127], v[96:99], v[132:135]
  s_waitcnt vmcnt(5)
  v_mfma_f32_16x16x32_bf16 v[132:135], v[124:127], v[100:103], v[132:135]
  s_waitcnt vmcnt(4)
  v_mfma_f32_16x16x32_bf16 v[132:135], v[124:127], v[104:107], v[132:135]
  s_waitcnt vmcnt(3)
  v_mfma_f32_16x16x32_bf16 v[136:139], v[124:127], v[108:111], 0
  s_waitcnt vmcnt(2)
  v_mfma_f32_16x16x32_bf16 v[136:139], v[124:127], v[112:115], v[136:139]
  s_waitcnt vmcnt(1)
  v_mfma_f32_16x16x32_bf16 v[136:139], v[124:127], v[116:119], v[136:139]
  s_waitcnt vmcnt(0)
  v_mfma_f32_16x16x32_bf16 v[136:139], v[124:127], v[120:123], v[136:139]
  v_add_f32 v13, v128, v132
  s_nop 6
  v_add_f32 v13, v13, v136
  v_cmp_u_f32 vcc, v13, v13
  s_mov_b32 s93, 1
  s_cbranch_vccz L_kgd_12
L_kg_11:
  s_add_u32 s59, s60, 0
  buffer_load_dwordx4 v[76:79], v36, s[12:15], s59 offen sc1
  s_add_u32 s59, s60, 12288
  buffer_load_dwordx4 v[80:83], v36, s[12:15], s59 offen sc1
  s_add_u32 s59, s60, 24576
  buffer_load_dwordx4 v[84:87], v36, s[12:15], s59 offen sc1
  s_add_u32 s59, s60, 36864
  buffer_load_dwordx4 v[88:91], v36, s[12:15], s59 offen sc1
  s_add_u32 s59, s60, 256
  buffer_load_dwordx4 v[92:95], v36, s[12:15], s59 offen sc1
  s_add_u32 s59, s60, 12544
  buffer_load_dwordx4 v[96:99], v36, s[12:15], s59 offen sc1
  s_add_u32 s59, s60, 24832
  buffer_load_dwordx4 v[100:103], v36, s[12:15], s59 offen sc1
  s_add_u32 s59, s60, 37120
  buffer_load_dwordx4 v[104:107], v36, s[12:15], s59 offen sc1
  s_add_u32 s59, s60, 512
  buffer_load_dwordx4 v[108:111], v36, s[12:15], s59 offen sc1
  s_add_u32 s59, s60, 12800
  buffer_load_dwordx4 v[112:115], v36, s[12:15], s59 offen sc1
  s_add_u32 s59, s60, 25088
  buffer_load_dwordx4 v[116:119], v36, s[12:15], s59 offen sc1
  s_add_u32 s59, s60, 37376
  buffer_load_dwordx4 v[120:123], v36, s[12:15], s59 offen sc1
  s_add_u32 s93, s93, 1
  s_waitcnt vmcnt(11)
  v_mfma_f32_16x16x32_bf16 v[128:131], v[124:127], v[76:79], 0
  s_waitcnt vmcnt(10)
  v_mfma_f32_16x16x32_bf16 v[128:131], v[124:127], v[80:83], v[128:131]
  s_waitcnt vmcnt(9)
  v_mfma_f32_16x16x32_bf16 v[128:131], v[124:127], v[84:87], v[128:131]
  s_waitcnt vmcnt(8)
  v_mfma_f32_16x16x32_bf16 v[128:131], v[124:127], v[88:91], v[128:131]
  s_waitcnt vmcnt(7)
  v_mfma_f32_16x16x32_bf16 v[132:135], v[124:127], v[92:95], 0
  s_waitcnt vmcnt(6)
  v_mfma_f32_16x16x32_bf16 v[132:135], v[124:127], v[96:99], v[132:135]
  s_waitcnt vmcnt(5)
  v_mfma_f32_16x16x32_bf16 v[132:135], v[124:127], v[100:103], v[132:135]
  s_waitcnt vmcnt(4)
  v_mfma_f32_16x16x32_bf16 v[132:135], v[124:127], v[104:107], v[132:135]
  s_waitcnt vmcnt(3)
  v_mfma_f32_16x16x32_bf16 v[136:139], v[124:127], v[108:111], 0
  s_waitcnt vmcnt(2)
  v_mfma_f32_16x16x32_bf16 v[136:139], v[124:127], v[112:115], v[136:139]
  s_waitcnt vmcnt(1)
  v_mfma_f32_16x16x32_bf16 v[136:139], v[124:127], v[116:119], v[136:139]
  s_waitcnt vmcnt(0)
  v_mfma_f32_16x16x32_bf16 v[136:139], v[124:127], v[120:123], v[136:139]
  v_add_f32 v13, v128, v132
  s_nop 6
  v_add_f32 v13, v13, v136
  v_cmp_u_f32 vcc, v13, v13
  s_cmp_gt_u32 s93, 5000
  s_cbranch_scc1 L_kgd_12
  s_cbranch_vccnz L_kg_11
L_kgd_12:
  s_mul_i32 s57, s49, 768
  s_add_u32 s57, s57, 10240
  v_lshlrev_b32 v12, 4, v10
  v_lshl_add_u32 v12, v11, 3, v12
  v_add_u32 v12, s57, v12
  v_cvt_pk_bf16_f32 v16, v128, v129
  v_cvt_pk_bf16_f32 v17, v130, v131
  v_cvt_pk_bf16_f32 v18, v132, v133
  v_cvt_pk_bf16_f32 v19, v134, v135
  v_cvt_pk_bf16_f32 v20, v136, v137
  v_cvt_pk_bf16_f32 v21, v138, v139
  s_mov_b32 exec_hi, 0
  ds_write_b64 v12, v[16:17] offset:0
  ds_write_b64 v12, v[18:19] offset:256
  ds_write_b64 v12, v[20:21] offset:512
  s_mov_b32 exec_hi, -1
  s_waitcnt lgkmcnt(0)
  v_mov_b32 v12, 163812
  v_mov_b32 v13, 1
  s_mov_b64 exec, 1
  ds_add_u32 v12, v13
  s_mov_b64 exec, -1
  v_mov_b32 v230, v140
  v_mov_b32 v231, v141
  v_mov_b32 v232, v142
  v_mov_b32 v233, v143
  v_mov_b32 v234, v144
  v_mov_b32 v235, v145
  v_mov_b32 v12, 163816
  s_mov_b32 s93, 0
L_lw_13:
  ds_read_b32 v13, v12
  s_add_u32 s93, s93, 1
  s_waitcnt lgkmcnt(0)
  v_readfirstlane_b32 s57, v13
  s_cmp_gt_u32 s93, 40000
  s_cbranch_scc1 L_lwd_14
  s_cmp_lt_u32 s57, 4
  s_cbranch_scc1 L_lw_13
L_lwd_14:
  v_mul_u32_u24 v16, 288, v75
  v_and_b32 v17, 3, v1
  v_lshl_add_u32 v16, v17, 3, v16
  v_add_u32 v17, 13568, v16
  s_lshl_b32 s57, s48, 5
  s_add_u32 s57, s57, 13312
  v_add_u32 v16, s57, v16
  v_add_u32 v18, 64512, v16
  v_add_u32 v19, 64512, v17
  ds_read_b64_tr_b16 v[120:121], v16 offset:0
  ds_read_b64_tr_b16 v[122:123], v16 offset:2304
  ds_read_b64_tr_b16 v[124:125], v16 offset:9216
  ds_read_b64_tr_b16 v[126:127], v16 offset:11520
  ds_read_b64_tr_b16 v[128:129], v16 offset:18432
  ds_read_b64_tr_b16 v[130:131], v16 offset:20736
  s_waitcnt lgkmcnt(6)
  ds_read_b64_tr_b16 v[132:133], v16 offset:27648
  ds_read_b64_tr_b16 v[134:135], v16 offset:29952
  ds_read_b64_tr_b16 v[136:137], v16 offset:36864
  ds_read_b64_tr_b16 v[138:139], v16 offset:39168
  ds_read_b64_tr_b16 v[140:141], v16 offset:46080
  ds_read_b64_tr_b16 v[142:143], v16 offset:48384
  s_waitcnt lgkmcnt(6)
  ds_read_b64_tr_b16 v[144:145], v16 offset:55296
  ds_read_b64_tr_b16 v[146:147], v16 offset:57600
  s_cmp_eq_u32 s48, 0
  s_cbranch_scc0 L_r9_15
  ds_read_b64_tr_b16 v[192:193], v17 offset:0
  ds_read_b64_tr_b16 v[194:195], v17 offset:2304
L_r9_15:
  s_cmp_eq_u32 s48, 1
  s_cbranch_scc0 L_r9_16
  ds_read_b64_tr_b16 v[192:193], v17 offset:9216
  ds_read_b64_tr_b16 v[194:195], v17 offset:11520
L_r9_16:
  s_cmp_eq_u32 s48, 2
  s_cbranch_scc0 L_r9_17
  ds_read_b64_tr_b16 v[192:193], v17 offset:18432
  ds_read_b64_tr_b16 v[194:195], v17 offset:20736
L_r9_17:
  s_cmp_eq_u32 s48, 3
  s_cbranch_scc0 L_r9_18
  ds_read_b64_tr_b16 v[192:193], v17 offset:27648
  ds_read_b64_tr_b16 v[194:195], v17 offset:29952
L_r9_18:
  s_cmp_eq_u32 s48, 4
  s_cbranch_scc0 L_r9_19
  ds_read_b64_tr_b16 v[192:193], v17 offset:36864
  ds_read_b64_tr_b16 v[194:195], v17 offset:39168
L_r9_19:
  s_cmp_eq_u32 s48, 5
  s_cbranch_scc0 L_r9_20
  ds_read_b64_tr_b16 v[192:193], v17 offset:46080
  ds_read_b64_tr_b16 v[194:195], v17 offset:48384
L_r9_20:
  s_cmp_eq_u32 s48, 6
  s_cbranch_scc0 L_r9_21
  ds_read_b64_tr_b16 v[192:193], v17 offset:55296
  ds_read_b64_tr_b16 v[194:195], v17 offset:57600
L_r9_21:
  s_waitcnt lgkmcnt(0)
  v_mov_b32 v12, 163820
  v_mov_b32 v13, 1
  s_mov_b64 exec, 1
  ds_add_u32 v12, v13
  s_mov_b64 exec, -1
  v_mov_b32 v12, 163820
  s_mov_b32 s93, 0
L_lw_22:
  ds_read_b32 v13, v12
  s_add_u32 s93, s93, 1
  s_waitcnt lgkmcnt(0)
  v_readfirstlane_b32 s57, v13
  s_cmp_gt_u32 s93, 40000
  s_cbranch_scc1 L_lwd_23
  s_cmp_lt_u32 s57, 8
  s_cbranch_scc1 L_lw_22
L_lwd_23:
  s_lshl_b32 s58, s49, 10
  s_mov_b32 s57, 290304
  s_add_u32 m0, s58, 13312
  s_nop 0
  buffer_load_dwordx4 v230, s[20:23], s57 offen  lds
  s_add_u32 m0, s58, 17408
  s_nop 0
  buffer_load_dwordx4 v231, s[20:23], s57 offen  lds
  s_mov_b32 s57, 331776
  s_add_u32 m0, s58, 22528
  s_nop 0
  buffer_load_dwordx4 v230, s[20:23], s57 offen  lds
  s_add_u32 m0, s58, 26624
  s_nop 0
  buffer_load_dwordx4 v231, s[20:23], s57 offen  lds
  s_mov_b32 s57, 373248
  s_add_u32 m0, s58, 31744
  s_nop 0
  buffer_load_dwordx4 v230, s[20:23], s57 offen  lds
  s_add_u32 m0, s58, 35840
  s_nop 0
  buffer_load_dwordx4 v231, s[20:23], s57 offen  lds
  s_mov_b32 s57, 414720
  s_add_u32 m0, s58, 40960
  s_nop 0
  buffer_load_dwordx4 v230, s[20:23], s57 offen  lds
  s_add_u32 m0, s58, 45056
  s_nop 0
  buffer_load_dwordx4 v231, s[20:23], s57 offen  lds
  s_mov_b32 s57, 456192
  s_add_u32 m0, s58, 50176
  s_nop 0
  buffer_load_dwordx4 v230, s[20:23], s57 offen  lds
  s_add_u32 m0, s58, 54272
  s_nop 0
  buffer_load_dwordx4 v231, s[20:23], s57 offen  lds
  s_mov_b32 s57, 497664
  s_add_u32 m0, s58, 59392
  s_nop 0
  buffer_load_dwordx4 v230, s[20:23], s57 offen  lds
  s_add_u32 m0, s58, 63488
  s_nop 0
  buffer_load_dwordx4 v231, s[20:23], s57 offen  lds
  s_mov_b32 s57, 539136
  s_add_u32 m0, s58, 68608
  s_nop 0
  buffer_load_dwordx4 v230, s[20:23], s57 offen  lds
  s_add_u32 m0, s58, 72704
  s_nop 0
  buffer_load_dwordx4 v231, s[20:23], s57 offen  lds
  s_mov_b32 s57, 580608
  s_add_u32 m0, s58, 77824
  s_nop 0
  buffer_load_dwordx4 v230, s[20:23], s57 offen  lds
  s_add_u32 m0, s58, 81920
  s_nop 0
  buffer_load_dwordx4 v231, s[20:23], s57 offen  lds
  s_mov_b32 s57, 622080
  s_add_u32 m0, s58, 87040
  s_nop 0
  buffer_load_dwordx4 v230, s[20:23], s57 offen  lds
  s_add_u32 m0, s58, 91136
  s_nop 0
  buffer_load_dwordx4 v231, s[20:23], s57 offen  lds
  s_mov_b32 s57, 0
  s_add_u32 m0, s58, 96256
  s_nop 0
  buffer_load_dwordx4 v233, s[20:23], s57 offen  lds
  s_add_u32 m0, s58, 100352
  s_nop 0
  buffer_load_dwordx4 v234, s[20:23], s57 offen  lds
  s_mov_b32 s57, 331776
  s_add_u32 m0, s58, 105472
  s_nop 0
  buffer_load_dwordx4 v233, s[20:23], s57 offen  lds
  s_add_u32 m0, s58, 109568
  s_nop 0
  buffer_load_dwordx4 v234, s[20:23], s57 offen  lds
  s_add_u32 s59, s49, 0
  s_min_u32 s59, s59, 10
  s_mul_i32 s57, s59, 9216
  s_add_u32 m0, s57, 21504
  s_add_u32 s59, s59, 7
  s_cmp_ge_u32 s59, 16
  s_cbranch_scc1 L_l8_24
  s_mul_i32 s57, s59, 41472
  buffer_load_dwordx4 v232, s[20:23], s57 offen  lds
  s_branch L_l8_25
L_l8_24:
  s_sub_u32 s59, s59, 16
  s_mul_i32 s57, s59, 331776
  buffer_load_dwordx4 v235, s[20:23], s57 offen  lds
L_l8_25:
  s_add_u32 s59, s49, 4
  s_min_u32 s59, s59, 10
  s_mul_i32 s57, s59, 9216
  s_add_u32 m0, s57, 21504
  s_add_u32 s59, s59, 7
  s_cmp_ge_u32 s59, 16
  s_cbranch_scc1 L_l8_26
  s_mul_i32 s57, s59, 41472
  buffer_load_dwordx4 v232, s[20:23], s57 offen  lds
  s_branch L_l8_27
L_l8_26:
  s_sub_u32 s59, s59, 16
  s_mul_i32 s57, s59, 331776
  buffer_load_dwordx4 v235, s[20:23], s57 offen  lds
L_l8_27:
  s_add_u32 s59, s49, 8
  s_min_u32 s59, s59, 10
  s_mul_i32 s57, s59, 9216
  s_add_u32 m0, s57, 21504
  s_add_u32 s59, s59, 7
  s_cmp_ge_u32 s59, 16
  s_cbranch_scc1 L_l8_28
  s_mul_i32 s57, s59, 41472
  buffer_load_dwordx4 v232, s[20:23], s57 offen  lds
  s_branch L_l8_29
L_l8_28:
  s_sub_u32 s59, s59, 16
  s_mul_i32 s57, s59, 331776
  buffer_load_dwordx4 v235, s[20:23], s57 offen  lds
L_l8_29:
  v_lshlrev_b32 v12, 4, v1
  buffer_load_dwordx4 v[212:215], v12, s[44:47], 0 offen
  buffer_load_dwordx4 v[216:219], v12, s[44:47], 0 offen offset:1024
  s_waitcnt vmcnt(0)
  s_branch L_B2
L_V:
  s_lshl_b32 s57, s50, 7
  s_lshl_b32 s58, s49, 5
  s_add_u32 s57, s57, s58
  v_lshrrev_b32 v12, 3, v1
  v_add_u32 v12, s57, v12
  v_mul_u32_u24 v12, 1152, v12
  v_and_b32 v13, 7, v1
  v_xor_b32 v13, v13, v11
  v_lshlrev_b32 v13, 4, v13
  v_add_u32 v2, v12, v13
  v_xor_b32 v13, 64, v13
  v_add_u32 v12, 9216, v12
  v_add_u32 v3, v12, v13
  s_lshl_b32 s88, s49, 12
  s_waitcnt lgkmcnt(0)
  s_mov_b32 s4, s64
  s_mov_b32 s5, s65
  s_mov_b32 s6, 2359296
  s_mov_b32 s7, 0x20000
  s_lshl_b32 s59, s63, 7
  s_add_u32 s60, s59, 18432
  s_add_u32 m0, s88, 0
  s_nop 0
  buffer_load_dwordx4 v2, s[4:7], s59 offen  lds
  s_add_u32 m0, s88, 1024
  s_nop 0
  buffer_load_dwordx4 v3, s[4:7], s59 offen  lds
  s_add_u32 m0, s88, 2048
  s_nop 0
  buffer_load_dwordx4 v2, s[4:7], s60 offen  lds
  s_add_u32 m0, s88, 3072
  s_nop 0
  buffer_load_dwordx4 v3, s[4:7], s60 offen  lds
  s_mov_b32 s4, s64
  s_mov_b32 s5, s65
  s_mov_b32 s6, 2359296
  s_mov_b32 s7, 0x20000
  s_mov_b32 s8, s66
  s_mov_b32 s9, s67
  s_mov_b32 s10, 1990656
  s_mov_b32 s11, 0x20000
  s_mov_b32 s36, s68
  s_mov_b32 s37, s69
  s_mov_b32 s38, 20736
  s_mov_b32 s39, 0x20000
  s_mov_b32 s20, s70
  s_mov_b32 s21, s71
  s_mov_b32 s22, 663552
  s_mov_b32 s23, 0x20000
  s_mov_b32 s44, s74
  s_mov_b32 s45, s75
  s_mov_b32 s46, 1152
  s_mov_b32 s47, 0x20000
  s_mov_b32 s24, s76
  s_mov_b32 s25, s77
  s_mov_b32 s26, 5308416
  s_mov_b32 s27, 0x20000
  s_mov_b32 s28, s78
  s_mov_b32 s29, s79
  s_mov_b32 s30, 5308416
  s_mov_b32 s31, 0x20000
  s_mov_b32 s32, s80
  s_mov_b32 s33, s81
  s_mov_b32 s34, 5308416
  s_mov_b32 s35, 0x20000
  s_mov_b32 s16, s82
  s_mov_b32 s17, s83
  s_mov_b32 s18, 2359296
  s_mov_b32 s19, 0x20000
  s_mov_b32 s40, s84
  s_mov_b32 s41, s85
  s_mov_b32 s42, 256
  s_mov_b32 s43, 0x20000
  s_mov_b32 s12, s86
  s_mov_b32 s13, s87
  s_mov_b32 s14, 268435456
  s_mov_b32 s15, 0x20000
  s_mul_i32 s57, s51, 1296
  v_lshlrev_b32 v12, 2, v0
  v_cmp_gt_u32 vcc, 324, v0
  v_mov_b32 v13, 0x7fffffff
  s_nop 0
  v_cndmask_b32 v12, v13, v12, vcc
  buffer_load_dword v74, v12, s[36:39], s57 offen
  s_add_u32 s64, s63, 0
  s_sub_u32 s57, s64, 9
  s_cmp_ge_u32 s64, 9
  s_cselect_b32 s64, s57, s64
  s_lshl_b32 s64, s64, 7
  s_add_u32 s73, s64, 18432
  s_add_u32 s65, s63, 1
  s_sub_u32 s57, s65, 9
  s_cmp_ge_u32 s65, 9
  s_cselect_b32 s65, s57, s65
  s_lshl_b32 s65, s65, 7
  s_add_u32 s74, s65, 18432
  s_add_u32 s66, s63, 2
  s_sub_u32 s57, s66, 9
  s_cmp_ge_u32 s66, 9
  s_cselect_b32 s66, s57, s66
  s_lshl_b32 s66, s66, 7
  s_add_u32 s75, s66, 18432
  s_add_u32 s67, s63, 3
  s_sub_u32 s57, s67, 9
  s_cmp_ge_u32 s67, 9
  s_cselect_b32 s67, s57, s67
  s_lshl_b32 s67, s67, 7
  s_add_u32 s76, s67, 18432
  s_add_u32 s68, s63, 4
  s_sub_u32 s57, s68, 9
  s_cmp_ge_u32 s68, 9
  s_cselect_b32 s68, s57, s68
  s_lshl_b32 s68, s68, 7
  s_add_u32 s77, s68, 18432
  s_add_u32 s69, s63, 5
  s_sub_u32 s57, s69, 9
  s_cmp_ge_u32 s69, 9
  s_cselect_b32 s69, s57, s69
  s_lshl_b32 s69, s69, 7
  s_add_u32 s78, s69, 18432
  s_add_u32 s70, s63, 6
  s_sub_u32 s57, s70, 9
  s_cmp_ge_u32 s70, 9
  s_cselect_b32 s70, s57, s70
  s_lshl_b32 s70, s70, 7
  s_add_u32 s79, s70, 18432
  s_add_u32 s71, s63, 7
  s_sub_u32 s57, s71, 9
  s_cmp_ge_u32 s71, 9
  s_cselect_b32 s71, s57, s71
  s_lshl_b32 s71, s71, 7
  s_add_u32 s80, s71, 18432
  s_add_u32 s72, s63, 8
  s_sub_u32 s57, s72, 9
  s_cmp_ge_u32 s72, 9
  s_cselect_b32 s72, s57, s72
  s_lshl_b32 s72, s72, 7
  s_add_u32 s81, s72, 18432
  s_lshl_b32 s57, s54, 3
  s_lshr_b32 s58, s55, 2
  s_add_u32 s52, s57, s58
  s_and_b32 s53, s55, 3
  s_lshl_b32 s57, s49, 5
  v_add_u32 v12, s57, v10
  v_lshlrev_b32 v12, 7, v12
  v_lshrrev_b32 v13, 1, v10
  v_xor_b32 v13, v13, v11
  v_lshlrev_b32 v13, 4, v13
  v_add_u32 v6, v12, v13
  v_xor_b32 v7, 64, v6
  v_lshrrev_b32 v12, 1, v11
  v_lshlrev_b32 v12, 4, v12
  v_and_b32 v13, 1, v11
  v_lshlrev_b32 v13, 2, v13
  v_lshrrev_b32 v14, 2, v10
  v_add3_u32 v75, v12, v13, v14
  v_and_b32 v13, 3, v1
  v_mul_u32_u24 v14, 160, v75
  v_add_u32 v14, s56, v14
  v_lshlrev_b32 v15, 3, v13
  v_add_u32 v8, v14, v15
  v_mov_b32 v52, 0x3f803f80
  v_mov_b32 v53, 0x3f803f80
  v_mov_b32 v54, 0x3f803f80
  v_mov_b32 v55, 0x3f803f80
  s_mov_b32 s92, 0x3fb8aa3b
  v_mul_u32_u24 v12, 52, v1
  v_lshrrev_b32 v12, 8, v12
  v_mul_u32_u24 v13, 5, v12
  v_sub_u32 v13, v1, v13
  v_lshlrev_b32 v13, 4, v13
  v_add_u32 v13, s62, v13
  v_add_u32 v14, 0, v12
  v_and_b32 v15, 0xfffffff3, v14
  v_and_b32 v16, 4, v14
  v_lshl_or_b32 v15, v16, 1, v15
  v_and_b32 v16, 8, v14
  v_lshrrev_b32 v16, 1, v16
  v_or_b32 v15, v15, v16
  v_mul_u32_u24 v15, 3456, v15
  v_add_u32 v5, v15, v13
  v_add_u32 v14, 11, v12
  v_and_b32 v15, 0xfffffff3, v14
  v_and_b32 v16, 4, v14
  v_lshl_or_b32 v15, v16, 1, v15
  v_and_b32 v16, 8, v14
  v_lshrrev_b32 v16, 1, v16
  v_or_b32 v15, v15, v16
  v_mul_u32_u24 v15, 3456, v15
  v_add_u32 v108, v15, v13
  v_add_u32 v14, 22, v12
  v_and_b32 v15, 0xfffffff3, v14
  v_and_b32 v16, 4, v14
  v_lshl_or_b32 v15, v16, 1, v15
  v_and_b32 v16, 8, v14
  v_lshrrev_b32 v16, 1, v16
  v_or_b32 v15, v15, v16
  v_mul_u32_u24 v15, 3456, v15
  v_add_u32 v109, v15, v13
  s_add_u32 m0, s88, 26624
  s_nop 0
  buffer_load_dwordx4 v2, s[4:7], s65 offen  lds
  s_add_u32 m0, s88, 27648
  s_nop 0
  buffer_load_dwordx4 v3, s[4:7], s65 offen  lds
  s_add_u32 m0, s88, 28672
  s_nop 0
  buffer_load_dwordx4 v2, s[4:7], s74 offen  lds
  s_add_u32 m0, s88, 29696
  s_nop 0
  buffer_load_dwordx4 v3, s[4:7], s74 offen  lds
  s_lshr_b32 s58, s55, 3
  s_lshr_b32 s59, s58, 1
  s_lshl_b32 s59, s59, 3
  s_and_b32 s57, s55, 7
  s_add_u32 s59, s59, s57
  s_mul_i32 s59, s59, 324
  s_mul_i32 s57, s49, 81
  s_add_u32 s59, s59, s57
  v_add_u32 v15, s59, v1
  s_and_b32 s58, s58, 1
  s_lshr_b32 s57, s54, 2
  s_cmp_eq_u32 s58, s57
  s_cselect_b32 s58, 41, 0
  v_cmp_gt_u32 vcc, s58, v1
  v_mov_b32 v12, 0x7fffffff
  v_mov_b32 v14, 0
  v_cndmask_b32 v12, v12, v14, vcc
  v_add_u32 v13, 0, v15
  v_lshlrev_b32 v13, 7, v13
  v_or_b32 v13, v13, v12
  s_mov_b32 m0, 153600
  s_nop 0
  buffer_load_dword v13, s[20:23], 0 offen  lds
  v_add_u32 v13, 41, v15
  v_lshlrev_b32 v13, 7, v13
  v_or_b32 v13, v13, v12
  s_mov_b32 m0, 153600
  s_nop 0
  buffer_load_dword v13, s[20:23], 0 offen  lds
  s_waitcnt vmcnt(6)
  s_waitcnt lgkmcnt(0)
  s_barrier
  v_cmp_lt_u32 vcc, 161, v0
  v_mov_b32 v12, 0
  v_mov_b32 v13, 162
  v_cndmask_b32 v12, v12, v13, vcc
  v_sub_u32 v12, v0, v12
  v_mov_b32 v14, 0
  v_mov_b32 v13, 18
  v_cndmask_b32 v13, v14, v13, vcc
  v_mul_u32_u24 v14, 57, v12
  v_lshrrev_b32 v14, 9, v14
  v_mul_u32_u24 v15, 9, v14
  v_sub_u32 v15, v12, v15
  v_lshl_add_u32 v15, v15, 1, v13
  v_mul_u32_u24 v15, 96, v15
  v_add_u32 v14, v14, v13
  v_lshl_add_u32 v15, v14, 1, v15
  v_add_u32 v15, 159744, v15
  v_cmp_gt_u32 vcc, 324, v0
  s_nop 0
  s_and_saveexec_b64 s[94:95], vcc
  s_cbranch_execz L_ws_30
  ds_write_b16 v15, v74
  ds_write_b16_d16_hi v15, v74 offset:96
L_ws_30:
  s_mov_b64 exec, s[94:95]
  ds_read_b128 v[112:115], v6 offset:0
  ds_read_b128 v[116:119], v6 offset:2048
  ds_read_b64_tr_b16 v[76:77], v8 offset:16464
  ds_read_b64_tr_b16 v[78:79], v8 offset:17744
  ds_read_b64_tr_b16 v[80:81], v8 offset:16504
  ds_read_b64_tr_b16 v[82:83], v8 offset:17784
  ds_read_b128 v[120:123], v7 offset:0
  ds_read_b128 v[124:127], v7 offset:2048
  ds_read_b64_tr_b16 v[84:85], v8 offset:21584
  ds_read_b64_tr_b16 v[86:87], v8 offset:22864
  ds_read_b64_tr_b16 v[88:89], v8 offset:21624
  ds_read_b64_tr_b16 v[90:91], v8 offset:22904
  s_add_u32 m0, s88, 53248
  s_nop 0
  buffer_load_dwordx4 v2, s[4:7], s66 offen  lds
  s_add_u32 m0, s88, 54272
  s_nop 0
  buffer_load_dwordx4 v3, s[4:7], s66 offen  lds
  s_add_u32 m0, s88, 55296
  s_nop 0
  buffer_load_dwordx4 v2, s[4:7], s75 offen  lds
  s_add_u32 m0, s88, 56320
  s_nop 0
  buffer_load_dwordx4 v3, s[4:7], s75 offen  lds
  s_waitcnt lgkmcnt(0)
  s_waitcnt vmcnt(6)
  s_barrier
  v_add_u32 v6, 26624, v6
  v_add_u32 v7, 26624, v7
  v_add_u32 v8, 26624, v8
  v_mfma_f32_16x16x32_bf16 v[16:19], v[76:79], v[112:115], 0
  ds_read_b128 v[128:131], v6 offset:0
  ds_read_b128 v[132:135], v6 offset:2048
  v_mfma_f32_16x16x32_bf16 v[20:23], v[76:79], v[116:119], 0
  ds_read_b64_tr_b16 v[92:93], v8 offset:16464
  v_mfma_f32_16x16x32_bf16 v[40:43], v[76:79], v[52:55], 0
  ds_read_b64_tr_b16 v[94:95], v8 offset:17744
  v_mfma_f32_16x16x32_bf16 v[24:27], v[80:83], v[112:115], 0
  ds_read_b64_tr_b16 v[96:97], v8 offset:16504
  v_mfma_f32_16x16x32_bf16 v[28:31], v[80:83], v[116:119], 0
  ds_read_b64_tr_b16 v[98:99], v8 offset:17784
  v_mfma_f32_16x16x32_bf16 v[44:47], v[80:83], v[52:55], 0
  ds_read_b128 v[136:139], v7 offset:0
  ds_read_b128 v[140:143], v7 offset:2048
  v_mfma_f32_16x16x32_bf16 v[32:35], v[112:115], v[112:115], 0
  ds_read_b64_tr_b16 v[100:101], v8 offset:21584
  v_mfma_f32_16x16x32_bf16 v[36:39], v[116:119], v[116:119], 0
  ds_read_b64_tr_b16 v[102:103], v8 offset:22864
  v_mfma_f32_16x16x32_bf16 v[16:19], v[84:87], v[120:123], v[16:19]
  ds_read_b64_tr_b16 v[104:105], v8 offset:21624
  v_mfma_f32_16x16x32_bf16 v[20:23], v[84:87], v[124:127], v[20:23]
  ds_read_b64_tr_b16 v[106:107], v8 offset:22904
  v_mfma_f32_16x16x32_bf16 v[40:43], v[84:87], v[52:55], v[40:43]
  s_add_u32 m0, s88, 79872
  s_nop 0
  buffer_load_dwordx4 v2, s[4:7], s67 offen  lds
  v_mfma_f32_16x16x32_bf16 v[24:27], v[88:91], v[120:123], v[24:27]
  s_add_u32 m0, s88, 80896
  s_nop 0
  buffer_load_dwordx4 v3, s[4:7], s67 offen  lds
  v_mfma_f32_16x16x32_bf16 v[28:31], v[88:91], v[124:127], v[28:31]
  v_mfma_f32_16x16x32_bf16 v[44:47], v[88:91], v[52:55], v[44:47]
  s_add_u32 m0, s88, 81920
  s_nop 0
  buffer_load_dwordx4 v2, s[4:7], s76 offen  lds
  v_mfma_f32_16x16x32_bf16 v[32:35], v[120:123], v[120:123], v[32:35]
  s_add_u32 m0, s88, 82944
  s_nop 0
  buffer_load_dwordx4 v3, s[4:7], s76 offen  lds
  v_mfma_f32_16x16x32_bf16 v[36:39], v[124:127], v[124:127], v[36:39]
  v_and_b32 v12, 7, v10
  v_add_u32 v12, 0, v12
  v_lshrrev_b32 v13, 3, v10
  v_mul_u32_u24 v13, 18, v13
  v_add_u32 v13, v13, v12
  v_cmp_gt_u32 vcc, 18, v12
  v_mov_b32 v14, 36
  s_nop 0
  v_cndmask_b32 v13, v14, v13, vcc
  v_mul_u32_u24 v13, 96, v13
  v_lshl_add_u32 v13, v11, 3, v13
  v_add_u32 v13, 159744, v13
  ds_read_b64 v[56:57], v13
  ds_read_b64 v[58:59], v13 offset:32
  ds_read_b64 v[60:61], v13 offset:64
  v_and_b32 v12, 7, v10
  v_add_u32 v12, 8, v12
  v_lshrrev_b32 v13, 3, v10
  v_mul_u32_u24 v13, 18, v13
  v_add_u32 v13, v13, v12
  v_cmp_gt_u32 vcc, 18, v12
  v_mov_b32 v14, 36
  s_nop 0
  v_cndmask_b32 v13, v14, v13, vcc
  v_mul_u32_u24 v13, 96, v13
  v_lshl_add_u32 v13, v11, 3, v13
  v_add_u32 v13, 159744, v13
  ds_read_b64 v[62:63], v13
  ds_read_b64 v[64:65], v13 offset:32
  ds_read_b64 v[66:67], v13 offset:64
  v_and_b32 v12, 7, v10
  v_add_u32 v12, 16, v12
  v_lshrrev_b32 v13, 3, v10
  v_mul_u32_u24 v13, 18, v13
  v_add_u32 v13, v13, v12
  v_cmp_gt_u32 vcc, 18, v12
  v_mov_b32 v14, 36
  s_nop 0
  v_cndmask_b32 v13, v14, v13, vcc
  v_mul_u32_u24 v13, 96, v13
  v_lshl_add_u32 v13, v11, 3, v13
  v_add_u32 v13, 159744, v13
  ds_read_b64 v[68:69], v13
  ds_read_b64 v[70:71], v13 offset:32
  ds_read_b64 v[72:73], v13 offset:64
  s_waitcnt lgkmcnt(0)
  s_waitcnt vmcnt(4)
  s_barrier
  v_add_u32 v6, 26624, v6
  v_add_u32 v7, 26624, v7
  v_add_u32 v8, 26624, v8
  v_mfma_f32_16x16x32_bf16 v[16:19], v[92:95], v[128:131], v[16:19]
  ds_read_b128 v[144:147], v6 offset:0
  ds_read_b128 v[148:151], v6 offset:2048
  v_mfma_f32_16x16x32_bf16 v[20:23], v[92:95], v[132:135], v[20:23]
  ds_read_b64_tr_b16 v[76:77], v8 offset:16464
  v_mfma_f32_16x16x32_bf16 v[40:43], v[92:95], v[52:55], v[40:43]
  ds_read_b64_tr_b16 v[78:79], v8 offset:17744
  v_mfma_f32_16x16x32_bf16 v[24:27], v[96:99], v[128:131], v[24:27]
  ds_read_b64_tr_b16 v[80:81], v8 offset:16504
  v_mfma_f32_16x16x32_bf16 v[28:31], v[96:99], v[132:135], v[28:31]
  ds_read_b64_tr_b16 v[82:83], v8 offset:17784
  v_mfma_f32_16x16x32_bf16 v[44:47], v[96:99], v[52:55], v[44:47]
  ds_read_b128 v[152:155], v7 offset:0
  ds_read_b128 v[156:159], v7 offset:2048
  v_mfma_f32_16x16x32_bf16 v[32:35], v[128:131], v[128:131], v[32:35]
  ds_read_b64_tr_b16 v[84:85], v8 offset:21584
  v_mfma_f32_16x16x32_bf16 v[36:39], v[132:135], v[132:135], v[36:39]
  ds_read_b64_tr_b16 v[86:87], v8 offset:22864
  v_mfma_f32_16x16x32_bf16 v[16:19], v[100:103], v[136:139], v[16:19]
  ds_read_b64_tr_b16 v[88:89], v8 offset:21624
  v_mfma_f32_16x16x32_bf16 v[20:23], v[100:103], v[140:143], v[20:23]
  ds_read_b64_tr_b16 v[90:91], v8 offset:22904
  v_mfma_f32_16x16x32_bf16 v[40:43], v[100:103], v[52:55], v[40:43]
  s_add_u32 m0, s88, 0
  s_nop 0
  buffer_load_dwordx4 v2, s[4:7], s68 offen  lds
  v_mfma_f32_16x16x32_bf16 v[24:27], v[104:107], v[136:139], v[24:27]
  s_add_u32 m0, s88, 1024
  s_nop 0
  buffer_load_dwordx4 v3, s[4:7], s68 offen  lds
  v_mfma_f32_16x16x32_bf16 v[28:31], v[104:107], v[140:143], v[28:31]
  v_mfma_f32_16x16x32_bf16 v[44:47], v[104:107], v[52:55], v[44:47]
  s_add_u32 m0, s88, 2048
  s_nop 0
  buffer_load_dwordx4 v2, s[4:7], s77 offen  lds
  v_mfma_f32_16x16x32_bf16 v[32:35], v[136:139], v[136:139], v[32:35]
  s_add_u32 m0, s88, 3072
  s_nop 0
  buffer_load_dwordx4 v3, s[4:7], s77 offen  lds
  v_mfma_f32_16x16x32_bf16 v[36:39], v[140:143], v[140:143], v[36:39]
  s_waitcnt lgkmcnt(0)
  s_waitcnt vmcnt(4)
  s_barrier
  v_add_u32 v6, 26624, v6
  v_add_u32 v7, 26624, v7
  v_add_u32 v8, 26624, v8
  v_mfma_f32_16x16x32_bf16 v[16:19], v[76:79], v[144:147], v[16:19]
  ds_read_b128 v[160:163], v6 offset:0
  ds_read_b128 v[164:167], v6 offset:2048
  v_mfma_f32_16x16x32_bf16 v[20:23], v[76:79], v[148:151], v[20:23]
  ds_read_b64_tr_b16 v[92:93], v8 offset:16464
  v_mfma_f32_16x16x32_bf16 v[40:43], v[76:79], v[52:55], v[40:43]
  ds_read_b64_tr_b16 v[94:95], v8 offset:17744
  v_mfma_f32_16x16x32_bf16 v[24:27], v[80:83], v[144:147], v[24:27]
  ds_read_b64_tr_b16 v[96:97], v8 offset:16504
  v_mfma_f32_16x16x32_bf16 v[28:31], v[80:83], v[148:151], v[28:31]
  ds_read_b64_tr_b16 v[98:99], v8 offset:17784
  v_mfma_f32_16x16x32_bf16 v[44:47], v[80:83], v[52:55], v[44:47]
  ds_read_b128 v[168:171], v7 offset:0
  ds_read_b128 v[172:175], v7 offset:2048
  v_mfma_f32_16x16x32_bf16 v[32:35], v[144:147], v[144:147], v[32:35]
  ds_read_b64_tr_b16 v[100:101], v8 offset:21584
  v_mfma_f32_16x16x32_bf16 v[36:39], v[148:151], v[148:151], v[36:39]
  ds_read_b64_tr_b16 v[102:103], v8 offset:22864
  v_mfma_f32_16x16x32_bf16 v[16:19], v[84:87], v[152:155], v[16:19]
  ds_read_b64_tr_b16 v[104:105], v8 offset:21624
  v_mfma_f32_16x16x32_bf16 v[20:23], v[84:87], v[156:159], v[20:23]
  ds_read_b64_tr_b16 v[106:107], v8 offset:22904
  v_mfma_f32_16x16x32_bf16 v[40:43], v[84:87], v[52:55], v[40:43]
  s_add_u32 m0, s88, 26624
  s_nop 0
  buffer_load_dwordx4 v2, s[4:7], s69 offen  lds
  v_mfma_f32_16x16x32_bf16 v[24:27], v[88:91], v[152:155], v[24:27]
  s_add_u32 m0, s88, 27648
  s_nop 0
  buffer_load_dwordx4 v3, s[4:7], s69 offen  lds
  v_mfma_f32_16x16x32_bf16 v[28:31], v[88:91], v[156:159], v[28:31]
  v_mfma_f32_16x16x32_bf16 v[44:47], v[88:91], v[52:55], v[44:47]
  s_add_u32 m0, s88, 28672
  s_nop 0
  buffer_load_dwordx4 v2, s[4:7], s78 offen  lds
  v_mfma_f32_16x16x32_bf16 v[32:35], v[152:155], v[152:155], v[32:35]
  s_add_u32 m0, s88, 29696
  s_nop 0
  buffer_load_dwordx4 v3, s[4:7], s78 offen  lds
  v_mfma_f32_16x16x32_bf16 v[36:39], v[156:159], v[156:159], v[36:39]
  s_waitcnt lgkmcnt(0)
  s_waitcnt vmcnt(4)
  s_barrier
  v_add_u32 v6, 4294887424, v6
  v_add_u32 v7, 4294887424, v7
  v_add_u32 v8, 4294887424, v8
  v_mfma_f32_16x16x32_bf16 v[16:19], v[92:95], v[160:163], v[16:19]
  ds_read_b128 v[176:179], v6 offset:0
  ds_read_b128 v[180:183], v6 offset:2048
  v_mfma_f32_16x16x32_bf16 v[20:23], v[92:95], v[164:167], v[20:23]
  ds_read_b64_tr_b16 v[76:77], v8 offset:16464
  v_mfma_f32_16x16x32_bf16 v[40:43], v[92:95], v[52:55], v[40:43]
  ds_read_b64_tr_b16 v[78:79], v8 offset:17744
  v_mfma_f32_16x16x32_bf16 v[24:27], v[96:99], v[160:163], v[24:27]
  ds_read_b64_tr_b16 v[80:81], v8 offset:16504
  v_mfma_f32_16x16x32_bf16 v[28:31], v[96:99], v[164:167], v[28:31]
  ds_read_b64_tr_b16 v[82:83], v8 offset:17784
  v_mfma_f32_16x16x32_bf16 v[44:47], v[96:99], v[52:55], v[44:47]
  ds_read_b128 v[184:187], v7 offset:0
  ds_read_b128 v[188:191], v7 offset:2048
  v_mfma_f32_16x16x32_bf16 v[32:35], v[160:163], v[160:163], v[32:35]
  ds_read_b64_tr_b16 v[84:85], v8 offset:21584
  v_mfma_f32_16x16x32_bf16 v[36:39], v[164:167], v[164:167], v[36:39]
  ds_read_b64_tr_b16 v[86:87], v8 offset:22864
  v_mfma_f32_16x16x32_bf16 v[16:19], v[100:103], v[168:171], v[16:19]
  ds_read_b64_tr_b16 v[88:89], v8 offset:21624
  v_mfma_f32_16x16x32_bf16 v[20:23], v[100:103], v[172:175], v[20:23]
  ds_read_b64_tr_b16 v[90:91], v8 offset:22904
  v_mfma_f32_16x16x32_bf16 v[40:43], v[100:103], v[52:55], v[40:43]
  s_add_u32 m0, s88, 53248
  s_nop 0
  buffer_load_dwordx4 v2, s[4:7], s70 offen  lds
  v_mfma_f32_16x16x32_bf16 v[24:27], v[104:107], v[168:171], v[24:27]
  s_add_u32 m0, s88, 54272
  s_nop 0
  buffer_load_dwordx4 v3, s[4:7], s70 offen  lds
  v_mfma_f32_16x16x32_bf16 v[28:31], v[104:107], v[172:175], v[28:31]
  v_mfma_f32_16x16x32_bf16 v[44:47], v[104:107], v[52:55], v[44:47]
  s_add_u32 m0, s88, 55296
  s_nop 0
  buffer_load_dwordx4 v2, s[4:7], s79 offen  lds
  v_mfma_f32_16x16x32_bf16 v[32:35], v[168:171], v[168:171], v[32:35]
  s_add_u32 m0, s88, 56320
  s_nop 0
  buffer_load_dwordx4 v3, s[4:7], s79 offen  lds
  v_mfma_f32_16x16x32_bf16 v[36:39], v[172:175], v[172:175], v[36:39]
  s_waitcnt lgkmcnt(0)
  s_waitcnt vmcnt(4)
  s_barrier
  v_add_u32 v6, 26624, v6
  v_add_u32 v7, 26624, v7
  v_add_u32 v8, 26624, v8
  v_mfma_f32_16x16x32_bf16 v[16:19], v[76:79], v[176:179], v[16:19]
  ds_read_b128 v[192:195], v6 offset:0
  ds_read_b128 v[196:199], v6 offset:2048
  v_mfma_f32_16x16x32_bf16 v[20:23], v[76:79], v[180:183], v[20:23]
  ds_read_b64_tr_b16 v[92:93], v8 offset:16464
  v_mfma_f32_16x16x32_bf16 v[40:43], v[76:79], v[52:55], v[40:43]
  ds_read_b64_tr_b16 v[94:95], v8 offset:17744
  v_mfma_f32_16x16x32_bf16 v[24:27], v[80:83], v[176:179], v[24:27]
  ds_read_b64_tr_b16 v[96:97], v8 offset:16504
  v_mfma_f32_16x16x32_bf16 v[28:31], v[80:83], v[180:183], v[28:31]
  ds_read_b64_tr_b16 v[98:99], v8 offset:17784
  v_mfma_f32_16x16x32_bf16 v[44:47], v[80:83], v[52:55], v[44:47]
  ds_read_b128 v[200:203], v7 offset:0
  ds_read_b128 v[204:207], v7 offset:2048
  v_mfma_f32_16x16x32_bf16 v[32:35], v[176:179], v[176:179], v[32:35]
  ds_read_b64_tr_b16 v[100:101], v8 offset:21584
  v_mfma_f32_16x16x32_bf16 v[36:39], v[180:183], v[180:183], v[36:39]
  ds_read_b64_tr_b16 v[102:103], v8 offset:22864
  v_mfma_f32_16x16x32_bf16 v[16:19], v[84:87], v[184:187], v[16:19]
  ds_read_b64_tr_b16 v[104:105], v8 offset:21624
  v_mfma_f32_16x16x32_bf16 v[20:23], v[84:87], v[188:191], v[20:23]
  ds_read_b64_tr_b16 v[106:107], v8 offset:22904
  v_mfma_f32_16x16x32_bf16 v[40:43], v[84:87], v[52:55], v[40:43]
  s_add_u32 m0, s88, 79872
  s_nop 0
  buffer_load_dwordx4 v2, s[4:7], s71 offen  lds
  v_mfma_f32_16x16x32_bf16 v[24:27], v[88:91], v[184:187], v[24:27]
  s_add_u32 m0, s88, 80896
  s_nop 0
  buffer_load_dwordx4 v3, s[4:7], s71 offen  lds
  v_mfma_f32_16x16x32_bf16 v[28:31], v[88:91], v[188:191], v[28:31]
  v_mfma_f32_16x16x32_bf16 v[44:47], v[88:91], v[52:55], v[44:47]
  s_add_u32 m0, s88, 81920
  s_nop 0
  buffer_load_dwordx4 v2, s[4:7], s80 offen  lds
  v_mfma_f32_16x16x32_bf16 v[32:35], v[184:187], v[184:187], v[32:35]
  s_add_u32 m0, s88, 82944
  s_nop 0
  buffer_load_dwordx4 v3, s[4:7], s80 offen  lds
  v_mfma_f32_16x16x32_bf16 v[36:39], v[188:191], v[188:191], v[36:39]
  s_waitcnt lgkmcnt(0)
  s_waitcnt vmcnt(4)
  s_barrier
  v_add_u32 v6, 26624, v6
  v_add_u32 v7, 26624, v7
  v_add_u32 v8, 26624, v8
  v_mfma_f32_16x16x32_bf16 v[16:19], v[92:95], v[192:195], v[16:19]
  ds_read_b128 v[208:211], v6 offset:0
  ds_read_b128 v[212:215], v6 offset:2048
  v_mfma_f32_16x16x32_bf16 v[20:23], v[92:95], v[196:199], v[20:23]
  ds_read_b64_tr_b16 v[76:77], v8 offset:16464
  v_mfma_f32_16x16x32_bf16 v[40:43], v[92:95], v[52:55], v[40:43]
  ds_read_b64_tr_b16 v[78:79], v8 offset:17744
  v_mfma_f32_16x16x32_bf16 v[24:27], v[96:99], v[192:195], v[24:27]
  ds_read_b64_tr_b16 v[80:81], v8 offset:16504
  v_mfma_f32_16x16x32_bf16 v[28:31], v[96:99], v[196:199], v[28:31]
  ds_read_b64_tr_b16 v[82:83], v8 offset:17784
  v_mfma_f32_16x16x32_bf16 v[44:47], v[96:99], v[52:55], v[44:47]
  ds_read_b128 v[216:219], v7 offset:0
  ds_read_b128 v[220:223], v7 offset:2048
  v_mfma_f32_16x16x32_bf16 v[32:35], v[192:195], v[192:195], v[32:35]
  ds_read_b64_tr_b16 v[84:85], v8 offset:21584
  v_mfma_f32_16x16x32_bf16 v[36:39], v[196:199], v[196:199], v[36:39]
  ds_read_b64_tr_b16 v[86:87], v8 offset:22864
  v_mfma_f32_16x16x32_bf16 v[16:19], v[100:103], v[200:203], v[16:19]
  ds_read_b64_tr_b16 v[88:89], v8 offset:21624
  v_mfma_f32_16x16x32_bf16 v[20:23], v[100:103], v[204:207], v[20:23]
  ds_read_b64_tr_b16 v[90:91], v8 offset:22904
  v_mfma_f32_16x16x32_bf16 v[40:43], v[100:103], v[52:55], v[40:43]
  s_add_u32 m0, s88, 0
  s_nop 0
  buffer_load_dwordx4 v2, s[4:7], s72 offen  lds
  v_mfma_f32_16x16x32_bf16 v[24:27], v[104:107], v[200:203], v[24:27]
  s_add_u32 m0, s88, 1024
  s_nop 0
  buffer_load_dwordx4 v3, s[4:7], s72 offen  lds
  v_mfma_f32_16x16x32_bf16 v[28:31], v[104:107], v[204:207], v[28:31]
  v_mfma_f32_16x16x32_bf16 v[44:47], v[104:107], v[52:55], v[44:47]
  s_add_u32 m0, s88, 2048
  s_nop 0
  buffer_load_dwordx4 v2, s[4:7], s81 offen  lds
  v_mfma_f32_16x16x32_bf16 v[32:35], v[200:203], v[200:203], v[32:35]
  s_add_u32 m0, s88, 3072
  s_nop 0
  buffer_load_dwordx4 v3, s[4:7], s81 offen  lds
  v_mfma_f32_16x16x32_bf16 v[36:39], v[204:207], v[204:207], v[36:39]
  s_waitcnt lgkmcnt(0)
  s_waitcnt vmcnt(4)
  s_barrier
  v_add_u32 v6, 26624, v6
  v_add_u32 v7, 26624, v7
  v_add_u32 v8, 26624, v8
  v_mfma_f32_16x16x32_bf16 v[16:19], v[76:79], v[208:211], v[16:19]
  ds_read_b128 v[224:227], v6 offset:0
  ds_read_b128 v[228:231], v6 offset:2048
  v_mfma_f32_16x16x32_bf16 v[20:23], v[76:79], v[212:215], v[20:23]
  ds_read_b64_tr_b16 v[92:93], v8 offset:16464
  v_mfma_f32_16x16x32_bf16 v[40:43], v[76:79], v[52:55], v[40:43]
  ds_read_b64_tr_b16 v[94:95], v8 offset:17744
  v_mfma_f32_16x16x32_bf16 v[24:27], v[80:83], v[208:211], v[24:27]
  ds_read_b64_tr_b16 v[96:97], v8 offset:16504
  v_mfma_f32_16x16x32_bf16 v[28:31], v[80:83], v[212:215], v[28:31]
  ds_read_b64_tr_b16 v[98:99], v8 offset:17784
  v_mfma_f32_16x16x32_bf16 v[44:47], v[80:83], v[52:55], v[44:47]
  ds_read_b128 v[232:235], v7 offset:0
  ds_read_b128 v[236:239], v7 offset:2048
  v_mfma_f32_16x16x32_bf16 v[32:35], v[208:211], v[208:211], v[32:35]
  ds_read_b64_tr_b16 v[100:101], v8 offset:21584
  v_mfma_f32_16x16x32_bf16 v[36:39], v[212:215], v[212:215], v[36:39]
  ds_read_b64_tr_b16 v[102:103], v8 offset:22864
  v_mfma_f32_16x16x32_bf16 v[16:19], v[84:87], v[216:219], v[16:19]
  ds_read_b64_tr_b16 v[104:105], v8 offset:21624
  v_mfma_f32_16x16x32_bf16 v[20:23], v[84:87], v[220:223], v[20:23]
  ds_read_b64_tr_b16 v[106:107], v8 offset:22904
  v_mfma_f32_16x16x32_bf16 v[40:43], v[84:87], v[52:55], v[40:43]
  s_add_u32 s58, s49, 0
  s_mul_i32 s59, s58, 2560
  s_add_u32 m0, s59, 106496
  s_lshl_b32 s57, s63, 1
  s_add_u32 s58, s58, s57
  s_sub_u32 s57, s58, 18
  s_cmp_ge_u32 s58, 18
  s_cselect_b32 s58, s57, s58
  s_mul_i32 s57, s58, 110592
  s_mov_b32 exec_hi, 0x7fffff
  buffer_load_dwordx4 v5, s[8:11], s57 offen  lds
  s_mov_b32 exec_hi, -1
  s_add_u32 s58, s49, 0
  s_mul_i32 s59, s58, 2560
  s_add_u32 m0, s59, 107376
  s_lshl_b32 s57, s63, 1
  s_add_u32 s58, s58, s57
  s_sub_u32 s57, s58, 18
  s_cmp_ge_u32 s58, 18
  s_cselect_b32 s58, s57, s58
  s_mul_i32 s57, s58, 110592
  s_mov_b32 exec_hi, 0x7fffff
  buffer_load_dwordx4 v108, s[8:11], s57 offen  lds
  s_mov_b32 exec_hi, -1
  v_mfma_f32_16x16x32_bf16 v[24:27], v[88:91], v[216:219], v[24:27]
  s_add_u32 s58, s49, 0
  s_mul_i32 s59, s58, 2560
  s_add_u32 m0, s59, 108256
  s_lshl_b32 s57, s63, 1
  s_add_u32 s58, s58, s57
  s_sub_u32 s57, s58, 18
  s_cmp_ge_u32 s58, 18
  s_cselect_b32 s58, s57, s58
  s_mul_i32 s57, s58, 110592
  s_mov_b32 exec_hi, 0x3ffff
  buffer_load_dwordx4 v109, s[8:11], s57 offen  lds
  s_mov_b32 exec_hi, -1
  v_mfma_f32_16x16x32_bf16 v[28:31], v[88:91], v[220:223], v[28:31]
  s_add_u32 s58, s49, 4
  s_mul_i32 s59, s58, 2560
  s_add_u32 m0, s59, 106496
  s_lshl_b32 s57, s63, 1
  s_add_u32 s58, s58, s57
  s_sub_u32 s57, s58, 18
  s_cmp_ge_u32 s58, 18
  s_cselect_b32 s58, s57, s58
  s_mul_i32 s57, s58, 110592
  s_mov_b32 exec_hi, 0x7fffff
  buffer_load_dwordx4 v5, s[8:11], s57 offen  lds
  s_mov_b32 exec_hi, -1
  v_mfma_f32_16x16x32_bf16 v[44:47], v[88:91], v[52:55], v[44:47]
  s_add_u32 s58, s49, 4
  s_mul_i32 s59, s58, 2560
  s_add_u32 m0, s59, 107376
  s_lshl_b32 s57, s63, 1
  s_add_u32 s58, s58, s57
  s_sub_u32 s57, s58, 18
  s_cmp_ge_u32 s58, 18
  s_cselect_b32 s58, s57, s58
  s_mul_i32 s57, s58, 110592
  s_mov_b32 exec_hi, 0x7fffff
  buffer_load_dwordx4 v108, s[8:11], s57 offen  lds
  s_mov_b32 exec_hi, -1
  v_mfma_f32_16x16x32_bf16 v[32:35], v[216:219], v[216:219], v[32:35]
  s_add_u32 s58, s49, 4
  s_mul_i32 s59, s58, 2560
  s_add_u32 m0, s59, 108256
  s_lshl_b32 s57, s63, 1
  s_add_u32 s58, s58, s57
  s_sub_u32 s57, s58, 18
  s_cmp_ge_u32 s58, 18
  s_cselect_b32 s58, s57, s58
  s_mul_i32 s57, s58, 110592
  s_mov_b32 exec_hi, 0x3ffff
  buffer_load_dwordx4 v109, s[8:11], s57 offen  lds
  s_mov_b32 exec_hi, -1
  v_mfma_f32_16x16x32_bf16 v[36:39], v[220:223], v[220:223], v[36:39]
  s_add_u32 s58, s49, 8
  s_mul_i32 s59, s58, 2560
  s_add_u32 m0, s59, 106496
  s_lshl_b32 s57, s63, 1
  s_add_u32 s58, s58, s57
  s_sub_u32 s57, s58, 18
  s_cmp_ge_u32 s58, 18
  s_cselect_b32 s58, s57, s58
  s_mul_i32 s57, s58, 110592
  s_mov_b32 exec_hi, 0x7fffff
  buffer_load_dwordx4 v5, s[8:11], s57 offen  lds
  s_mov_b32 exec_hi, -1
  s_waitcnt lgkmcnt(0)
  s_waitcnt vmcnt(7)
  s_barrier
  v_add_u32 v6, 4294887424, v6
  v_add_u32 v7, 4294887424, v7
  v_add_u32 v8, 4294887424, v8
  v_mfma_f32_16x16x32_bf16 v[16:19], v[92:95], v[224:227], v[16:19]
  ds_read_b128 v[240:243], v6 offset:0
  ds_read_b128 v[244:247], v6 offset:2048
  v_mfma_f32_16x16x32_bf16 v[20:23], v[92:95], v[228:231], v[20:23]
  ds_read_b64_tr_b16 v[76:77], v8 offset:16464
  v_mfma_f32_16x16x32_bf16 v[40:43], v[92:95], v[52:55], v[40:43]
  ds_read_b64_tr_b16 v[78:79], v8 offset:17744
  v_mfma_f32_16x16x32_bf16 v[24:27], v[96:99], v[224:227], v[24:27]
  ds_read_b64_tr_b16 v[80:81], v8 offset:16504
  v_mfma_f32_16x16x32_bf16 v[28:31], v[96:99], v[228:231], v[28:31]
  ds_read_b64_tr_b16 v[82:83], v8 offset:17784
  v_mfma_f32_16x16x32_bf16 v[44:47], v[96:99], v[52:55], v[44:47]
  ds_read_b128 v[248:251], v7 offset:0
  ds_read_b128 v[252:255], v7 offset:2048
  v_mfma_f32_16x16x32_bf16 v[32:35], v[224:227], v[224:227], v[32:35]
  ds_read_b64_tr_b16 v[84:85], v8 offset:21584
  v_mfma_f32_16x16x32_bf16 v[36:39], v[228:231], v[228:231], v[36:39]
  ds_read_b64_tr_b16 v[86:87], v8 offset:22864
  v_mfma_f32_16x16x32_bf16 v[16:19], v[100:103], v[232:235], v[16:19]
  ds_read_b64_tr_b16 v[88:89], v8 offset:21624
  v_mfma_f32_16x16x32_bf16 v[20:23], v[100:103], v[236:239], v[20:23]
  ds_read_b64_tr_b16 v[90:91], v8 offset:22904
  v_mfma_f32_16x16x32_bf16 v[40:43], v[100:103], v[52:55], v[40:43]
  s_add_u32 s58, s49, 8
  s_mul_i32 s59, s58, 2560
  s_add_u32 m0, s59, 107376
  s_lshl_b32 s57, s63, 1
  s_add_u32 s58, s58, s57
  s_sub_u32 s57, s58, 18
  s_cmp_ge_u32 s58, 18
  s_cselect_b32 s58, s57, s58
  s_mul_i32 s57, s58, 110592
  s_mov_b32 exec_hi, 0x7fffff
  buffer_load_dwordx4 v108, s[8:11], s57 offen  lds
  s_mov_b32 exec_hi, -1
  v_mfma_f32_16x16x32_bf16 v[24:27], v[104:107], v[232:235], v[24:27]
  s_add_u32 s58, s49, 8
  s_mul_i32 s59, s58, 2560
  s_add_u32 m0, s59, 108256
  s_lshl_b32 s57, s63, 1
  s_add_u32 s58, s58, s57
  s_sub_u32 s57, s58, 18
  s_cmp_ge_u32 s58, 18
  s_cselect_b32 s58, s57, s58
  s_mul_i32 s57, s58, 110592
  s_mov_b32 exec_hi, 0x3ffff
  buffer_load_dwordx4 v109, s[8:11], s57 offen  lds
  s_mov_b32 exec_hi, -1
  v_mfma_f32_16x16x32_bf16 v[28:31], v[104:107], v[236:239], v[28:31]
  s_add_u32 s58, s49, 12
  s_mul_i32 s59, s58, 2560
  s_add_u32 m0, s59, 106496
  s_lshl_b32 s57, s63, 1
  s_add_u32 s58, s58, s57
  s_sub_u32 s57, s58, 18
  s_cmp_ge_u32 s58, 18
  s_cselect_b32 s58, s57, s58
  s_mul_i32 s57, s58, 110592
  s_mov_b32 exec_hi, 0x7fffff
  buffer_load_dwordx4 v5, s[8:11], s57 offen  lds
  s_mov_b32 exec_hi, -1
  v_mfma_f32_16x16x32_bf16 v[44:47], v[104:107], v[52:55], v[44:47]
  s_add_u32 s58, s49, 12
  s_mul_i32 s59, s58, 2560
  s_add_u32 m0, s59, 107376
  s_lshl_b32 s57, s63, 1
  s_add_u32 s58, s58, s57
  s_sub_u32 s57, s58, 18
  s_cmp_ge_u32 s58, 18
  s_cselect_b32 s58, s57, s58
  s_mul_i32 s57, s58, 110592
  s_mov_b32 exec_hi, 0x7fffff
  buffer_load_dwordx4 v108, s[8:11], s57 offen  lds
  s_mov_b32 exec_hi, -1
  v_mfma_f32_16x16x32_bf16 v[32:35], v[232:235], v[232:235], v[32:35]
  s_add_u32 s58, s49, 12
  s_mul_i32 s59, s58, 2560
  s_add_u32 m0, s59, 108256
  s_lshl_b32 s57, s63, 1
  s_add_u32 s58, s58, s57
  s_sub_u32 s57, s58, 18
  s_cmp_ge_u32 s58, 18
  s_cselect_b32 s58, s57, s58
  s_mul_i32 s57, s58, 110592
  s_mov_b32 exec_hi, 0x3ffff
  buffer_load_dwordx4 v109, s[8:11], s57 offen  lds
  s_mov_b32 exec_hi, -1
  v_mfma_f32_16x16x32_bf16 v[36:39], v[236:239], v[236:239], v[36:39]
  s_and_b32 s60, s49, 1
  s_add_u32 s60, s60, 16
  s_sub_u32 s60, s60, s49
  s_add_u32 s58, s49, s60
  s_mul_i32 s59, s58, 2560
  s_add_u32 m0, s59, 108256
  s_lshl_b32 s57, s63, 1
  s_add_u32 s58, s58, s57
  s_sub_u32 s57, s58, 18
  s_cmp_ge_u32 s58, 18
  s_cselect_b32 s58, s57, s58
  s_mul_i32 s57, s58, 110592
  s_mov_b32 exec_hi, 0x3ffff
  buffer_load_dwordx4 v109, s[8:11], s57 offen  lds
  s_mov_b32 exec_hi, -1
  s_lshr_b32 s60, s49, 1
  s_add_u32 s60, s60, 16
  s_sub_u32 s60, s60, s49
  s_bitcmp1_b32 s49, 0
  s_cbranch_scc1 L_q_31
  s_add_u32 s58, s49, s60
  s_mul_i32 s59, s58, 2560
  s_add_u32 m0, s59, 106496
  s_lshl_b32 s57, s63, 1
  s_add_u32 s58, s58, s57
  s_sub_u32 s57, s58, 18
  s_cmp_ge_u32 s58, 18
  s_cselect_b32 s58, s57, s58
  s_mul_i32 s57, s58, 110592
  s_mov_b32 exec_hi, 0x7fffff
  buffer_load_dwordx4 v5, s[8:11], s57 offen  lds
  s_mov_b32 exec_hi, -1
  s_branch L_q_32
L_q_31:
  s_add_u32 s58, s49, s60
  s_mul_i32 s59, s58, 2560
  s_add_u32 m0, s59, 107376
  s_lshl_b32 s57, s63, 1
  s_add_u32 s58, s58, s57
  s_sub_u32 s57, s58, 18
  s_cmp_ge_u32 s58, 18
  s_cselect_b32 s58, s57, s58
  s_mul_i32 s57, s58, 110592
  s_mov_b32 exec_hi, 0x7fffff
  buffer_load_dwordx4 v108, s[8:11], s57 offen  lds
  s_mov_b32 exec_hi, -1
L_q_32:
  s_waitcnt lgkmcnt(0)
  v_mfma_f32_16x16x32_bf16 v[16:19], v[76:79], v[240:243], v[16:19]
  v_mfma_f32_16x16x32_bf16 v[20:23], v[76:79], v[244:247], v[20:23]
  v_mfma_f32_16x16x32_bf16 v[40:43], v[76:79], v[52:55], v[40:43]
  v_mfma_f32_16x16x32_bf16 v[24:27], v[80:83], v[240:243], v[24:27]
  v_mfma_f32_16x16x32_bf16 v[28:31], v[80:83], v[244:247], v[28:31]
  v_mfma_f32_16x16x32_bf16 v[44:47], v[80:83], v[52:55], v[44:47]
  v_mfma_f32_16x16x32_bf16 v[32:35], v[240:243], v[240:243], v[32:35]
  v_mfma_f32_16x16x32_bf16 v[36:39], v[244:247], v[244:247], v[36:39]
  v_mfma_f32_16x16x32_bf16 v[16:19], v[84:87], v[248:251], v[16:19]
  v_mfma_f32_16x16x32_bf16 v[20:23], v[84:87], v[252:255], v[20:23]
  v_mfma_f32_16x16x32_bf16 v[40:43], v[84:87], v[52:55], v[40:43]
  v_mfma_f32_16x16x32_bf16 v[24:27], v[88:91], v[248:251], v[24:27]
  v_mfma_f32_16x16x32_bf16 v[28:31], v[88:91], v[252:255], v[28:31]
  v_mfma_f32_16x16x32_bf16 v[44:47], v[88:91], v[52:55], v[44:47]
  v_mfma_f32_16x16x32_bf16 v[32:35], v[248:251], v[248:251], v[32:35]
  v_mfma_f32_16x16x32_bf16 v[36:39], v[252:255], v[252:255], v[36:39]
  v_and_b32 v13, 3, v10
  s_nop 5
  v_mov_b32 v110, v32
  v_mov_b32 v111, v36
  v_cmp_eq_u32 vcc, 1, v13
  s_nop 1
  v_cndmask_b32 v110, v110, v33, vcc
  v_cndmask_b32 v111, v111, v37, vcc
  v_cmp_eq_u32 vcc, 2, v13
  s_nop 1
  v_cndmask_b32 v110, v110, v34, vcc
  v_cndmask_b32 v111, v111, v38, vcc
  v_cmp_eq_u32 vcc, 3, v13
  s_nop 1
  v_cndmask_b32 v110, v110, v35, vcc
  v_cndmask_b32 v111, v111, v39, vcc
  s_lshl_b32 s57, s49, 5
  v_add_u32 v12, s57, v10
  v_lshlrev_b32 v12, 3, v12
  v_add_u32 v12, 159744, v12
  s_mov_b32 exec_lo, 0x00f0000f
  s_mov_b32 exec_hi, 0xf0000f00
  ds_write_b32 v12, v110 offset:4
  ds_write_b32 v12, v111 offset:132
  s_mov_b64 exec, -1
  s_waitcnt lgkmcnt(0)
  s_barrier
  ds_read_b64 v[76:77], v12 offset:0
  ds_read_b64 v[78:79], v12 offset:128
  s_waitcnt lgkmcnt(0)
  v_mul_f32 v76, 0x3ae38e39, v76
  v_mul_f32 v77, 0x3ae38e39, v77
  v_fma_f32 v77, -v76, v76, v77
  v_max_f32 v77, 0, v77
  v_add_f32 v77, 0x3727c5ac, v77
  v_rsq_f32 v2, v77
  s_nop 0
  v_mul_f32 v3, v76, v2
  v_sub_f32 v3, 0, v3
  v_mul_f32 v78, 0x3ae38e39, v78
  v_mul_f32 v79, 0x3ae38e39, v79
  v_fma_f32 v79, -v78, v78, v79
  v_max_f32 v79, 0, v79
  v_add_f32 v79, 0x3727c5ac, v79
  v_rsq_f32 v4, v79
  s_nop 0
  v_mul_f32 v5, v78, v4
  v_sub_f32 v5, 0, v5
  s_lshl_b32 s57, s49, 5
  v_add_u32 v12, s57, v10
  v_mul_u32_u24 v12, 80, v12
  v_lshl_add_u32 v12, v11, 3, v12
  v_mov_b32 v14, v3
  v_pk_mul_f32 v[96:97], v[40:41], v[14:15] op_sel_hi:[1,0]
  v_pk_mul_f32 v[98:99], v[42:43], v[14:15] op_sel_hi:[1,0]
  v_pk_fma_f32 v[16:17], v[16:17], v[2:3], v[96:97] op_sel_hi:[1,0,1]
  v_pk_fma_f32 v[18:19], v[18:19], v[2:3], v[98:99] op_sel_hi:[1,0,1]
  v_cvt_pk_bf16_f32 v100, v16, v17
  v_cvt_pk_bf16_f32 v101, v18, v19
  v_pk_mul_f32 v[96:97], v[44:45], v[14:15] op_sel_hi:[1,0]
  v_pk_mul_f32 v[98:99], v[46:47], v[14:15] op_sel_hi:[1,0]
  v_pk_fma_f32 v[24:25], v[24:25], v[2:3], v[96:97] op_sel_hi:[1,0,1]
  v_pk_fma_f32 v[26:27], v[26:27], v[2:3], v[98:99] op_sel_hi:[1,0,1]
  v_cvt_pk_bf16_f32 v102, v24, v25
  v_cvt_pk_bf16_f32 v103, v26, v27
  v_mov_b32 v14, v5
  v_pk_mul_f32 v[96:97], v[40:41], v[14:15] op_sel_hi:[1,0]
  v_pk_mul_f32 v[98:99], v[42:43], v[14:15] op_sel_hi:[1,0]
  v_pk_fma_f32 v[20:21], v[20:21], v[4:5], v[96:97] op_sel_hi:[1,0,1]
  v_pk_fma_f32 v[22:23], v[22:23], v[4:5], v[98:99] op_sel_hi:[1,0,1]
  v_cvt_pk_bf16_f32 v104, v20, v21
  v_cvt_pk_bf16_f32 v105, v22, v23
  v_pk_mul_f32 v[96:97], v[44:45], v[14:15] op_sel_hi:[1,0]
  v_pk_mul_f32 v[98:99], v[46:47], v[14:15] op_sel_hi:[1,0]
  v_pk_fma_f32 v[28:29], v[28:29], v[4:5], v[96:97] op_sel_hi:[1,0,1]
  v_pk_fma_f32 v[30:31], v[30:31], v[4:5], v[98:99] op_sel_hi:[1,0,1]
  v_cvt_pk_bf16_f32 v106, v28, v29
  v_cvt_pk_bf16_f32 v107, v30, v31
  ds_write_b64 v12, v[100:101] offset:0
  ds_write_b64 v12, v[102:103] offset:40
  ds_write_b64 v12, v[104:105] offset:1280
  ds_write_b64 v12, v[106:107] offset:1320
  s_waitcnt lgkmcnt(0)
  v_mov_b32 v12, 163808
  v_mov_b32 v13, 1
  s_mov_b64 exec, 1
  ds_add_u32 v12, v13
  s_mov_b64 exec, -1
  s_waitcnt vmcnt(0)
  s_waitcnt lgkmcnt(0)
  v_mov_b32 v12, 163828
  v_mov_b32 v13, 1
  s_mov_b64 exec, 1
  ds_add_u32 v12, v13
  s_mov_b64 exec, -1
  v_mul_u32_u24 v12, 80, v75
  v_and_b32 v13, 3, v1
  v_lshl_add_u32 v12, v13, 3, v12
  v_add_u32 v12, s56, v12
  v_add_u32 v8, 106496, v12
  v_lshlrev_b32 v13, 3, v13
  v_sub_u32 v6, v8, v13
  v_add_u32 v6, 64, v6
  s_mul_i32 s58, s49, 2560
  v_add_u32 v9, s58, v8
  v_add_u32 v7, s58, v6
  s_cmp_lt_u32 s49, 2
  s_cselect_b32 s58, 0x3f803f80, 0
  v_mov_b32 v12, 163828
  s_mov_b32 s93, 0
L_lw_33:
  ds_read_b32 v13, v12
  s_add_u32 s93, s93, 1
  s_waitcnt lgkmcnt(0)
  v_readfirstlane_b32 s57, v13
  s_cmp_gt_u32 s93, 40000
  s_cbranch_scc1 L_lwd_34
  s_cmp_lt_u32 s57, 4
  s_cbranch_scc1 L_lw_33
L_lwd_34:
  v_mov_b32 v12, 163808
  s_mov_b32 s93, 0
L_lw_35:
  ds_read_b32 v13, v12
  s_add_u32 s93, s93, 1
  s_waitcnt lgkmcnt(0)
  v_readfirstlane_b32 s57, v13
  s_cmp_gt_u32 s93, 40000
  s_cbranch_scc1 L_lwd_36
  s_cmp_lt_u32 s57, 8
  s_cbranch_scc1 L_lw_35
L_lwd_36:
  ds_read_b64_tr_b16 v[76:77], v8 offset:0
  ds_read_b64_tr_b16 v[78:79], v8 offset:640
  ds_read_b64_tr_b16 v[80:81], v8 offset:32
  ds_read_b64_tr_b16 v[82:83], v8 offset:672
  ds_read_b64_tr_b16 v[84:85], v6 offset:0
  ds_read_b64_tr_b16 v[86:87], v6 offset:640
  ds_read_b64_tr_b16 v[88:89], v8 offset:2560
  ds_read_b64_tr_b16 v[90:91], v8 offset:3200
  ds_read_b64_tr_b16 v[92:93], v8 offset:2592
  ds_read_b64_tr_b16 v[94:95], v8 offset:3232
  ds_read_b64_tr_b16 v[96:97], v6 offset:2560
  ds_read_b64_tr_b16 v[98:99], v6 offset:3200
  s_waitcnt lgkmcnt(6)
  v_mfma_f32_16x16x32_bf16 v[16:19], v[76:79], v[112:115], 0
  ds_read_b64_tr_b16 v[100:101], v8 offset:5120
  v_mfma_f32_16x16x32_bf16 v[20:23], v[76:79], v[116:119], 0
  ds_read_b64_tr_b16 v[102:103], v8 offset:5760
  v_mfma_f32_16x16x32_bf16 v[24:27], v[80:83], v[112:115], 0
  ds_read_b64_tr_b16 v[104:105], v8 offset:5152
  v_mfma_f32_16x16x32_bf16 v[28:31], v[80:83], v[116:119], 0
  ds_read_b64_tr_b16 v[106:107], v8 offset:5792
  v_mfma_f32_16x16x32_bf16 v[32:35], v[84:87], v[112:115], 0
  ds_read_b64_tr_b16 v[108:109], v6 offset:5120
  v_mfma_f32_16x16x32_bf16 v[36:39], v[84:87], v[116:119], 0
  ds_read_b64_tr_b16 v[110:111], v6 offset:5760
  s_waitcnt lgkmcnt(6)
  v_mfma_f32_16x16x32_bf16 v[16:19], v[88:91], v[120:123], v[16:19]
  ds_read_b64_tr_b16 v[76:77], v8 offset:7680
  v_mfma_f32_16x16x32_bf16 v[20:23], v[88:91], v[124:127], v[20:23]
  ds_read_b64_tr_b16 v[78:79], v8 offset:8320
  v_mfma_f32_16x16x32_bf16 v[24:27], v[92:95], v[120:123], v[24:27]
  ds_read_b64_tr_b16 v[80:81], v8 offset:7712
  v_mfma_f32_16x16x32_bf16 v[28:31], v[92:95], v[124:127], v[28:31]
  ds_read_b64_tr_b16 v[82:83], v8 offset:8352
  v_mfma_f32_16x16x32_bf16 v[32:35], v[96:99], v[120:123], v[32:35]
  ds_read_b64_tr_b16 v[84:85], v6 offset:7680
  v_mfma_f32_16x16x32_bf16 v[36:39], v[96:99], v[124:127], v[36:39]
  ds_read_b64_tr_b16 v[86:87], v6 offset:8320
  s_waitcnt lgkmcnt(6)
  v_mfma_f32_16x16x32_bf16 v[16:19], v[100:103], v[128:131], v[16:19]
  ds_read_b64_tr_b16 v[88:89], v8 offset:10240
  v_mfma_f32_16x16x32_bf16 v[20:23], v[100:103], v[132:135], v[20:23]
  ds_read_b64_tr_b16 v[90:91], v8 offset:10880
  v_mfma_f32_16x16x32_bf16 v[24:27], v[104:107], v[128:131], v[24:27]
  ds_read_b64_tr_b16 v[92:93], v8 offset:10272
  v_mfma_f32_16x16x32_bf16 v[28:31], v[104:107], v[132:135], v[28:31]
  ds_read_b64_tr_b16 v[94:95], v8 offset:10912
  v_mfma_f32_16x16x32_bf16 v[32:35], v[108:111], v[128:131], v[32:35]
  ds_read_b64_tr_b16 v[96:97], v6 offset:10240
  v_mfma_f32_16x16x32_bf16 v[36:39], v[108:111], v[132:135], v[36:39]
  ds_read_b64_tr_b16 v[98:99], v6 offset:10880
  s_waitcnt lgkmcnt(6)
  v_mfma_f32_16x16x32_bf16 v[16:19], v[76:79], v[136:139], v[16:19]
  ds_read_b64_tr_b16 v[100:101], v8 offset:12800
  v_mfma_f32_16x16x32_bf16 v[20:23], v[76:79], v[140:143], v[20:23]
  ds_read_b64_tr_b16 v[102:103], v8 offset:13440
  v_mfma_f32_16x16x32_bf16 v[24:27], v[80:83], v[136:139], v[24:27]
  ds_read_b64_tr_b16 v[104:105], v8 offset:12832
  v_mfma_f32_16x16x32_bf16 v[28:31], v[80:83], v[140:143], v[28:31]
  ds_read_b64_tr_b16 v[106:107], v8 offset:13472
  v_mfma_f32_16x16x32_bf16 v[32:35], v[84:87], v[136:139], v[32:35]
  ds_read_b64_tr_b16 v[108:109], v6 offset:12800
  v_mfma_f32_16x16x32_bf16 v[36:39], v[84:87], v[140:143], v[36:39]
  ds_read_b64_tr_b16 v[110:111], v6 offset:13440
  s_waitcnt lgkmcnt(6)
  v_mfma_f32_16x16x32_bf16 v[16:19], v[88:91], v[144:147], v[16:19]
  ds_read_b64_tr_b16 v[76:77], v8 offset:15360
  v_mfma_f32_16x16x32_bf16 v[20:23], v[88:91], v[148:151], v[20:23]
  ds_read_b64_tr_b16 v[78:79], v8 offset:16000
  v_mfma_f32_16x16x32_bf16 v[24:27], v[92:95], v[144:147], v[24:27]
  ds_read_b64_tr_b16 v[80:81], v8 offset:15392
  v_mfma_f32_16x16x32_bf16 v[28:31], v[92:95], v[148:151], v[28:31]
  ds_read_b64_tr_b16 v[82:83], v8 offset:16032
  v_mfma_f32_16x16x32_bf16 v[32:35], v[96:99], v[144:147], v[32:35]
  ds_read_b64_tr_b16 v[84:85], v6 offset:15360
  v_mfma_f32_16x16x32_bf16 v[36:39], v[96:99], v[148:151], v[36:39]
  ds_read_b64_tr_b16 v[86:87], v6 offset:16000
  s_waitcnt lgkmcnt(6)
  v_mfma_f32_16x16x32_bf16 v[16:19], v[100:103], v[152:155], v[16:19]
  ds_read_b64_tr_b16 v[88:89], v8 offset:17920
  v_mfma_f32_16x16x32_bf16 v[20:23], v[100:103], v[156:159], v[20:23]
  ds_read_b64_tr_b16 v[90:91], v8 offset:18560
  v_mfma_f32_16x16x32_bf16 v[24:27], v[104:107], v[152:155], v[24:27]
  ds_read_b64_tr_b16 v[92:93], v8 offset:17952
  v_mfma_f32_16x16x32_bf16 v[28:31], v[104:107], v[156:159], v[28:31]
  ds_read_b64_tr_b16 v[94:95], v8 offset:18592
  v_mfma_f32_16x16x32_bf16 v[32:35], v[108:111], v[152:155], v[32:35]
  ds_read_b64_tr_b16 v[96:97], v6 offset:17920
  v_mfma_f32_16x16x32_bf16 v[36:39], v[108:111], v[156:159], v[36:39]
  ds_read_b64_tr_b16 v[98:99], v6 offset:18560
  s_waitcnt lgkmcnt(6)
  v_mfma_f32_16x16x32_bf16 v[16:19], v[76:79], v[160:163], v[16:19]
  ds_read_b64_tr_b16 v[100:101], v8 offset:20480
  v_mfma_f32_16x16x32_bf16 v[20:23], v[76:79], v[164:167], v[20:23]
  ds_read_b64_tr_b16 v[102:103], v8 offset:21120
  v_mfma_f32_16x16x32_bf16 v[24:27], v[80:83], v[160:163], v[24:27]
  ds_read_b64_tr_b16 v[104:105], v8 offset:20512
  v_mfma_f32_16x16x32_bf16 v[28:31], v[80:83], v[164:167], v[28:31]
  ds_read_b64_tr_b16 v[106:107], v8 offset:21152
  v_mfma_f32_16x16x32_bf16 v[32:35], v[84:87], v[160:163], v[32:35]
  ds_read_b64_tr_b16 v[108:109], v6 offset:20480
  v_mfma_f32_16x16x32_bf16 v[36:39], v[84:87], v[164:167], v[36:39]
  ds_read_b64_tr_b16 v[110:111], v6 offset:21120
  s_waitcnt lgkmcnt(6)
  v_mfma_f32_16x16x32_bf16 v[16:19], v[88:91], v[168:171], v[16:19]
  ds_read_b64_tr_b16 v[76:77], v8 offset:23040
  v_mfma_f32_16x16x32_bf16 v[20:23], v[88:91], v[172:175], v[20:23]
  ds_read_b64_tr_b16 v[78:79], v8 offset:23680
  v_mfma_f32_16x16x32_bf16 v[24:27], v[92:95], v[168:171], v[24:27]
  ds_read_b64_tr_b16 v[80:81], v8 offset:23072
  v_mfma_f32_16x16x32_bf16 v[28:31], v[92:95], v[172:175], v[28:31]
  ds_read_b64_tr_b16 v[82:83], v8 offset:23712
  v_mfma_f32_16x16x32_bf16 v[32:35], v[96:99], v[168:171], v[32:35]
  ds_read_b64_tr_b16 v[84:85], v6 offset:23040
  v_mfma_f32_16x16x32_bf16 v[36:39], v[96:99], v[172:175], v[36:39]
  ds_read_b64_tr_b16 v[86:87], v6 offset:23680
  s_waitcnt lgkmcnt(6)
  v_mfma_f32_16x16x32_bf16 v[16:19], v[100:103], v[176:179], v[16:19]
  ds_read_b64_tr_b16 v[88:89], v8 offset:25600
  v_mfma_f32_16x16x32_bf16 v[20:23], v[100:103], v[180:183], v[20:23]
  ds_read_b64_tr_b16 v[90:91], v8 offset:26240
  v_mfma_f32_16x16x32_bf16 v[24:27], v[104:107], v[176:179], v[24:27]
  ds_read_b64_tr_b16 v[92:93], v8 offset:25632
  v_mfma_f32_16x16x32_bf16 v[28:31], v[104:107], v[180:183], v[28:31]
  ds_read_b64_tr_b16 v[94:95], v8 offset:26272
  v_mfma_f32_16x16x32_bf16 v[32:35], v[108:111], v[176:179], v[32:35]
  ds_read_b64_tr_b16 v[96:97], v6 offset:25600
  v_mfma_f32_16x16x32_bf16 v[36:39], v[108:111], v[180:183], v[36:39]
  ds_read_b64_tr_b16 v[98:99], v6 offset:26240
  s_waitcnt lgkmcnt(6)
  v_mfma_f32_16x16x32_bf16 v[16:19], v[76:79], v[184:187], v[16:19]
  ds_read_b64_tr_b16 v[100:101], v8 offset:28160
  v_mfma_f32_16x16x32_bf16 v[20:23], v[76:79], v[188:191], v[20:23]
  ds_read_b64_tr_b16 v[102:103], v8 offset:28800
  v_mfma_f32_16x16x32_bf16 v[24:27], v[80:83], v[184:187], v[24:27]
  ds_read_b64_tr_b16 v[104:105], v8 offset:28192
  v_mfma_f32_16x16x32_bf16 v[28:31], v[80:83], v[188:191], v[28:31]
  ds_read_b64_tr_b16 v[106:107], v8 offset:28832
  v_mfma_f32_16x16x32_bf16 v[32:35], v[84:87], v[184:187], v[32:35]
  ds_read_b64_tr_b16 v[108:109], v6 offset:28160
  v_mfma_f32_16x16x32_bf16 v[36:39], v[84:87], v[188:191], v[36:39]
  ds_read_b64_tr_b16 v[110:111], v6 offset:28800
  s_waitcnt lgkmcnt(6)
  v_mfma_f32_16x16x32_bf16 v[16:19], v[88:91], v[192:195], v[16:19]
  ds_read_b64_tr_b16 v[76:77], v8 offset:30720
  v_mfma_f32_16x16x32_bf16 v[20:23], v[88:91], v[196:199], v[20:23]
  ds_read_b64_tr_b16 v[78:79], v8 offset:31360
  v_mfma_f32_16x16x32_bf16 v[24:27], v[92:95], v[192:195], v[24:27]
  ds_read_b64_tr_b16 v[80:81], v8 offset:30752
  v_mfma_f32_16x16x32_bf16 v[28:31], v[92:95], v[196:199], v[28:31]
  ds_read_b64_tr_b16 v[82:83], v8 offset:31392
  v_mfma_f32_16x16x32_bf16 v[32:35], v[96:99], v[192:195], v[32:35]
  ds_read_b64_tr_b16 v[84:85], v6 offset:30720
  v_mfma_f32_16x16x32_bf16 v[36:39], v[96:99], v[196:199], v[36:39]
  ds_read_b64_tr_b16 v[86:87], v6 offset:31360
  s_waitcnt lgkmcnt(6)
  v_mfma_f32_16x16x32_bf16 v[16:19], v[100:103], v[200:203], v[16:19]
  ds_read_b64_tr_b16 v[88:89], v8 offset:33280
  v_mfma_f32_16x16x32_bf16 v[20:23], v[100:103], v[204:207], v[20:23]
  ds_read_b64_tr_b16 v[90:91], v8 offset:33920
  v_mfma_f32_16x16x32_bf16 v[24:27], v[104:107], v[200:203], v[24:27]
  ds_read_b64_tr_b16 v[92:93], v8 offset:33312
  v_mfma_f32_16x16x32_bf16 v[28:31], v[104:107], v[204:207], v[28:31]
  ds_read_b64_tr_b16 v[94:95], v8 offset:33952
  v_mfma_f32_16x16x32_bf16 v[32:35], v[108:111], v[200:203], v[32:35]
  ds_read_b64_tr_b16 v[96:97], v6 offset:33280
  v_mfma_f32_16x16x32_bf16 v[36:39], v[108:111], v[204:207], v[36:39]
  ds_read_b64_tr_b16 v[98:99], v6 offset:33920
  s_waitcnt lgkmcnt(6)
  v_mfma_f32_16x16x32_bf16 v[16:19], v[76:79], v[208:211], v[16:19]
  ds_read_b64_tr_b16 v[100:101], v8 offset:35840
  v_mfma_f32_16x16x32_bf16 v[20:23], v[76:79], v[212:215], v[20:23]
  ds_read_b64_tr_b16 v[102:103], v8 offset:36480
  v_mfma_f32_16x16x32_bf16 v[24:27], v[80:83], v[208:211], v[24:27]
  ds_read_b64_tr_b16 v[104:105], v8 offset:35872
  v_mfma_f32_16x16x32_bf16 v[28:31], v[80:83], v[212:215], v[28:31]
  ds_read_b64_tr_b16 v[106:107], v8 offset:36512
  v_mfma_f32_16x16x32_bf16 v[32:35], v[84:87], v[208:211], v[32:35]
  ds_read_b64_tr_b16 v[108:109], v6 offset:35840
  v_mfma_f32_16x16x32_bf16 v[36:39], v[84:87], v[212:215], v[36:39]
  ds_read_b64_tr_b16 v[110:111], v6 offset:36480
  s_waitcnt lgkmcnt(6)
  v_mfma_f32_16x16x32_bf16 v[16:19], v[88:91], v[216:219], v[16:19]
  ds_read_b64_tr_b16 v[76:77], v8 offset:38400
  v_mfma_f32_16x16x32_bf16 v[20:23], v[88:91], v[220:223], v[20:23]
  ds_read_b64_tr_b16 v[78:79], v8 offset:39040
  v_mfma_f32_16x16x32_bf16 v[24:27], v[92:95], v[216:219], v[24:27]
  ds_read_b64_tr_b16 v[80:81], v8 offset:38432
  v_mfma_f32_16x16x32_bf16 v[28:31], v[92:95], v[220:223], v[28:31]
  ds_read_b64_tr_b16 v[82:83], v8 offset:39072
  v_mfma_f32_16x16x32_bf16 v[32:35], v[96:99], v[216:219], v[32:35]
  ds_read_b64_tr_b16 v[84:85], v6 offset:38400
  v_mfma_f32_16x16x32_bf16 v[36:39], v[96:99], v[220:223], v[36:39]
  ds_read_b64_tr_b16 v[86:87], v6 offset:39040
  s_waitcnt lgkmcnt(6)
  v_mfma_f32_16x16x32_bf16 v[16:19], v[100:103], v[224:227], v[16:19]
  ds_read_b64_tr_b16 v[88:89], v8 offset:40960
  v_mfma_f32_16x16x32_bf16 v[20:23], v[100:103], v[228:231], v[20:23]
  ds_read_b64_tr_b16 v[90:91], v8 offset:41600
  v_mfma_f32_16x16x32_bf16 v[24:27], v[104:107], v[224:227], v[24:27]
  ds_read_b64_tr_b16 v[92:93], v8 offset:40992
  v_mfma_f32_16x16x32_bf16 v[28:31], v[104:107], v[228:231], v[28:31]
  ds_read_b64_tr_b16 v[94:95], v8 offset:41632
  v_mfma_f32_16x16x32_bf16 v[32:35], v[108:111], v[224:227], v[32:35]
  ds_read_b64_tr_b16 v[96:97], v6 offset:40960
  v_mfma_f32_16x16x32_bf16 v[36:39], v[108:111], v[228:231], v[36:39]
  ds_read_b64_tr_b16 v[98:99], v6 offset:41600
  s_waitcnt lgkmcnt(6)
  v_mfma_f32_16x16x32_bf16 v[16:19], v[76:79], v[232:235], v[16:19]
  ds_read_b64_tr_b16 v[100:101], v8 offset:43520
  v_mfma_f32_16x16x32_bf16 v[20:23], v[76:79], v[236:239], v[20:23]
  ds_read_b64_tr_b16 v[102:103], v8 offset:44160
  v_mfma_f32_16x16x32_bf16 v[24:27], v[80:83], v[232:235], v[24:27]
  ds_read_b64_tr_b16 v[104:105], v8 offset:43552
  v_mfma_f32_16x16x32_bf16 v[28:31], v[80:83], v[236:239], v[28:31]
  ds_read_b64_tr_b16 v[106:107], v8 offset:44192
  v_mfma_f32_16x16x32_bf16 v[32:35], v[84:87], v[232:235], v[32:35]
  ds_read_b64_tr_b16 v[108:109], v6 offset:43520
  v_mfma_f32_16x16x32_bf16 v[36:39], v[84:87], v[236:239], v[36:39]
  ds_read_b64_tr_b16 v[110:111], v6 offset:44160
  s_waitcnt lgkmcnt(6)
  v_mfma_f32_16x16x32_bf16 v[16:19], v[88:91], v[240:243], v[16:19]
  v_mfma_f32_16x16x32_bf16 v[20:23], v[88:91], v[244:247], v[20:23]
  v_mfma_f32_16x16x32_bf16 v[24:27], v[92:95], v[240:243], v[24:27]
  v_mfma_f32_16x16x32_bf16 v[28:31], v[92:95], v[244:247], v[28:31]
  v_mfma_f32_16x16x32_bf16 v[32:35], v[96:99], v[240:243], v[32:35]
  v_mfma_f32_16x16x32_bf16 v[36:39], v[96:99], v[244:247], v[36:39]
  s_waitcnt lgkmcnt(0)
  v_mfma_f32_16x16x32_bf16 v[16:19], v[100:103], v[248:251], v[16:19]
  v_mfma_f32_16x16x32_bf16 v[20:23], v[100:103], v[252:255], v[20:23]
  v_mfma_f32_16x16x32_bf16 v[24:27], v[104:107], v[248:251], v[24:27]
  v_mfma_f32_16x16x32_bf16 v[28:31], v[104:107], v[252:255], v[28:31]
  v_mfma_f32_16x16x32_bf16 v[32:35], v[108:111], v[248:251], v[32:35]
  v_mfma_f32_16x16x32_bf16 v[36:39], v[108:111], v[252:255], v[36:39]
  v_mov_b32 v112, s58
  v_mov_b32 v113, s58
  v_mov_b32 v114, s58
  v_mov_b32 v115, s58
  ds_read_b64_tr_b16 v[76:77], v9 offset:0
  ds_read_b64_tr_b16 v[78:79], v9 offset:640
  ds_read_b64_tr_b16 v[80:81], v9 offset:32
  ds_read_b64_tr_b16 v[82:83], v9 offset:672
  ds_read_b64_tr_b16 v[84:85], v7 offset:0
  ds_read_b64_tr_b16 v[86:87], v7 offset:640
  ds_read_b64_tr_b16 v[88:89], v9 offset:10240
  ds_read_b64_tr_b16 v[90:91], v9 offset:10880
  ds_read_b64_tr_b16 v[92:93], v9 offset:10272
  ds_read_b64_tr_b16 v[94:95], v9 offset:10912
  ds_read_b64_tr_b16 v[96:97], v7 offset:10240
  ds_read_b64_tr_b16 v[98:99], v7 offset:10880
  s_waitcnt lgkmcnt(6)
  v_mfma_f32_16x16x32_bf16 v[40:43], v[76:79], v[52:55], 0
  ds_read_b64_tr_b16 v[100:101], v9 offset:20480
  ds_read_b64_tr_b16 v[102:103], v9 offset:21120
  v_mfma_f32_16x16x32_bf16 v[44:47], v[80:83], v[52:55], 0
  ds_read_b64_tr_b16 v[104:105], v9 offset:20512
  ds_read_b64_tr_b16 v[106:107], v9 offset:21152
  v_mfma_f32_16x16x32_bf16 v[48:51], v[84:87], v[52:55], 0
  ds_read_b64_tr_b16 v[108:109], v7 offset:20480
  ds_read_b64_tr_b16 v[110:111], v7 offset:21120
  s_waitcnt lgkmcnt(6)
  v_mfma_f32_16x16x32_bf16 v[40:43], v[88:91], v[52:55], v[40:43]
  ds_read_b64_tr_b16 v[76:77], v9 offset:30720
  ds_read_b64_tr_b16 v[78:79], v9 offset:31360
  v_mfma_f32_16x16x32_bf16 v[44:47], v[92:95], v[52:55], v[44:47]
  ds_read_b64_tr_b16 v[80:81], v9 offset:30752
  ds_read_b64_tr_b16 v[82:83], v9 offset:31392
  v_mfma_f32_16x16x32_bf16 v[48:51], v[96:99], v[52:55], v[48:51]
  ds_read_b64_tr_b16 v[84:85], v7 offset:30720
  ds_read_b64_tr_b16 v[86:87], v7 offset:31360
  s_waitcnt lgkmcnt(6)
  s_add_u32 s59, s49, 16
  s_min_u32 s59, s59, 17
  s_mul_i32 s59, s59, 2560
  v_add_u32 v14, s59, v8
  v_add_u32 v15, s59, v6
  v_mfma_f32_16x16x32_bf16 v[40:43], v[100:103], v[52:55], v[40:43]
  ds_read_b64_tr_b16 v[88:89], v14 offset:0
  ds_read_b64_tr_b16 v[90:91], v14 offset:640
  v_mfma_f32_16x16x32_bf16 v[44:47], v[104:107], v[52:55], v[44:47]
  ds_read_b64_tr_b16 v[92:93], v14 offset:32
  ds_read_b64_tr_b16 v[94:95], v14 offset:672
  v_mfma_f32_16x16x32_bf16 v[48:51], v[108:111], v[52:55], v[48:51]
  ds_read_b64_tr_b16 v[96:97], v15 offset:0
  ds_read_b64_tr_b16 v[98:99], v15 offset:640
  s_waitcnt lgkmcnt(6)
  v_mfma_f32_16x16x32_bf16 v[40:43], v[76:79], v[52:55], v[40:43]
  v_mfma_f32_16x16x32_bf16 v[44:47], v[80:83], v[52:55], v[44:47]
  v_mfma_f32_16x16x32_bf16 v[48:51], v[84:87], v[52:55], v[48:51]
  s_waitcnt lgkmcnt(0)
  v_mfma_f32_16x16x32_bf16 v[40:43], v[88:91], v[112:115], v[40:43]
  v_mfma_f32_16x16x32_bf16 v[44:47], v[92:95], v[112:115], v[44:47]
  v_mfma_f32_16x16x32_bf16 v[48:51], v[96:99], v[112:115], v[48:51]
  s_mul_i32 s57, s49, 192
  v_lshlrev_b32 v13, 4, v11
  v_add_u32 v13, 152576, v13
  v_add_u32 v14, s57, v13
  s_mov_b32 exec_lo, 0x00010001
  s_mov_b32 exec_hi, 0x00010001
  ds_write_b128 v14, v[40:43] offset:0
  ds_write_b128 v14, v[44:47] offset:64
  ds_write_b128 v14, v[48:51] offset:128
  s_mov_b64 exec, -1
  s_waitcnt lgkmcnt(0)
  v_mov_b32 v12, 163824
  v_mov_b32 v14, 1
  s_mov_b64 exec, 1
  ds_add_u32 v12, v14
  s_mov_b64 exec, -1
  v_mov_b32 v204, 0
  v_mov_b32 v205, 0
  v_mov_b32 v206, 0
  v_mov_b32 v207, 0
  v_mov_b32 v208, 0
  v_mov_b32 v209, 0
  v_mov_b32 v210, 0
  v_mov_b32 v211, 0
  v_mov_b32 v212, 0
  v_mov_b32 v213, 0
  v_mov_b32 v214, 0
  v_mov_b32 v215, 0
  v_mov_b32 v216, 0
  v_mov_b32 v217, 0
  v_mov_b32 v218, 0
  v_mov_b32 v219, 0
  v_mov_b32 v220, 0
  v_mov_b32 v221, 0
  v_mov_b32 v222, 0
  v_mov_b32 v223, 0
  v_mov_b32 v224, 0
  v_mov_b32 v225, 0
  v_mov_b32 v226, 0
  v_mov_b32 v227, 0
  v_mov_b32 v228, 0
  v_mov_b32 v229, 0
  v_mov_b32 v230, 0
  v_mov_b32 v231, 0
  v_mov_b32 v232, 0
  v_mov_b32 v233, 0
  v_mov_b32 v234, 0
  v_mov_b32 v235, 0
  v_mov_b32 v236, 0
  v_mov_b32 v237, 0
  v_mov_b32 v238, 0
  v_mov_b32 v239, 0
  v_mov_b32 v240, 0
  v_mov_b32 v241, 0
  v_mov_b32 v242, 0
  v_mov_b32 v243, 0
  v_mov_b32 v12, 163824
  s_mov_b32 s93, 0
L_lw_37:
  ds_read_b32 v14, v12
  s_add_u32 s93, s93, 1
  s_waitcnt lgkmcnt(0)
  v_readfirstlane_b32 s57, v14
  s_cmp_gt_u32 s93, 40000
  s_cbranch_scc1 L_lwd_38
  s_cmp_lt_u32 s57, 4
  s_cbranch_scc1 L_lw_37
L_lwd_38:
  ds_read_b128 v[244:247], v13 offset:0
  ds_read_b128 v[248:251], v13 offset:64
  ds_read_b128 v[252:255], v13 offset:128
  ds_read_b128 v[76:79], v13 offset:192
  ds_read_b128 v[80:83], v13 offset:256
  ds_read_b128 v[84:87], v13 offset:320
  ds_read_b128 v[120:123], v13 offset:384
  ds_read_b128 v[124:127], v13 offset:448
  ds_read_b128 v[128:131], v13 offset:512
  ds_read_b128 v[132:135], v13 offset:576
  ds_read_b128 v[136:139], v13 offset:640
  ds_read_b128 v[140:143], v13 offset:704
  s_waitcnt lgkmcnt(0)
  v_pk_add_f32 v[244:245], v[244:245], v[76:77]
  v_pk_add_f32 v[120:121], v[120:121], v[132:133]
  v_pk_add_f32 v[246:247], v[246:247], v[78:79]
  v_pk_add_f32 v[122:123], v[122:123], v[134:135]
  v_pk_add_f32 v[248:249], v[248:249], v[80:81]
  v_pk_add_f32 v[124:125], v[124:125], v[136:137]
  v_pk_add_f32 v[250:251], v[250:251], v[82:83]
  v_pk_add_f32 v[126:127], v[126:127], v[138:139]
  v_pk_add_f32 v[252:253], v[252:253], v[84:85]
  v_pk_add_f32 v[128:129], v[128:129], v[140:141]
  v_pk_add_f32 v[254:255], v[254:255], v[86:87]
  v_pk_add_f32 v[130:131], v[130:131], v[142:143]
  v_pk_add_f32 v[244:245], v[244:245], v[120:121]
  v_pk_add_f32 v[246:247], v[246:247], v[122:123]
  v_pk_add_f32 v[248:249], v[248:249], v[124:125]
  v_pk_add_f32 v[250:251], v[250:251], v[126:127]
  v_pk_add_f32 v[252:253], v[252:253], v[128:129]
  v_pk_add_f32 v[254:255], v[254:255], v[130:131]
  v_mov_b32 v14, v3
  v_pk_mul_f32 v[108:109], v[244:245], v[14:15] op_sel_hi:[1,0]
  v_pk_mul_f32 v[110:111], v[246:247], v[14:15] op_sel_hi:[1,0]
  v_pk_fma_f32 v[16:17], v[16:17], v[2:3], v[108:109] op_sel_hi:[1,0,1]
  v_pk_fma_f32 v[18:19], v[18:19], v[2:3], v[110:111] op_sel_hi:[1,0,1]
  v_cvt_pk_bf16_f32 v96, v16, v17
  v_cvt_pk_bf16_f32 v97, v18, v19
  v_pk_mul_f32 v[108:109], v[248:249], v[14:15] op_sel_hi:[1,0]
  v_pk_mul_f32 v[110:111], v[250:251], v[14:15] op_sel_hi:[1,0]
  v_pk_fma_f32 v[24:25], v[24:25], v[2:3], v[108:109] op_sel_hi:[1,0,1]
  v_pk_fma_f32 v[26:27], v[26:27], v[2:3], v[110:111] op_sel_hi:[1,0,1]
  v_cvt_pk_bf16_f32 v98, v24, v25
  v_cvt_pk_bf16_f32 v99, v26, v27
  v_pk_mul_f32 v[108:109], v[252:253], v[14:15] op_sel_hi:[1,0]
  v_pk_mul_f32 v[110:111], v[254:255], v[14:15] op_sel_hi:[1,0]
  v_pk_fma_f32 v[32:33], v[32:33], v[2:3], v[108:109] op_sel_hi:[1,0,1]
  v_pk_fma_f32 v[34:35], v[34:35], v[2:3], v[110:111] op_sel_hi:[1,0,1]
  v_cvt_pk_bf16_f32 v100, v32, v33
  v_cvt_pk_bf16_f32 v101, v34, v35
  v_mov_b32 v14, v5
  v_pk_mul_f32 v[108:109], v[244:245], v[14:15] op_sel_hi:[1,0]
  v_pk_mul_f32 v[110:111], v[246:247], v[14:15] op_sel_hi:[1,0]
  v_pk_fma_f32 v[20:21], v[20:21], v[4:5], v[108:109] op_sel_hi:[1,0,1]
  v_pk_fma_f32 v[22:23], v[22:23], v[4:5], v[110:111] op_sel_hi:[1,0,1]
  v_cvt_pk_bf16_f32 v102, v20, v21
  v_cvt_pk_bf16_f32 v103, v22, v23
  v_pk_mul_f32 v[108:109], v[248:249], v[14:15] op_sel_hi:[1,0]
  v_pk_mul_f32 v[110:111], v[250:251], v[14:15] op_sel_hi:[1,0]
  v_pk_fma_f32 v[28:29], v[28:29], v[4:5], v[108:109] op_sel_hi:[1,0,1]
  v_pk_fma_f32 v[30:31], v[30:31], v[4:5], v[110:111] op_sel_hi:[1,0,1]
  v_cvt_pk_bf16_f32 v104, v28, v29
  v_cvt_pk_bf16_f32 v105, v30, v31
  v_pk_mul_f32 v[108:109], v[252:253], v[14:15] op_sel_hi:[1,0]
  v_pk_mul_f32 v[110:111], v[254:255], v[14:15] op_sel_hi:[1,0]
  v_pk_fma_f32 v[36:37], v[36:37], v[4:5], v[108:109] op_sel_hi:[1,0,1]
  v_pk_fma_f32 v[38:39], v[38:39], v[4:5], v[110:111] op_sel_hi:[1,0,1]
  v_cvt_pk_bf16_f32 v106, v36, v37
  v_cvt_pk_bf16_f32 v107, v38, v39
  v_mfma_f32_16x16x32_bf16 v[16:19], v[56:59], v[96:99], 0
  v_mfma_f32_16x16x32_bf16 v[20:23], v[56:59], v[102:105], 0
  v_mfma_f32_16x16x32_bf16 v[24:27], v[62:65], v[96:99], 0
  v_mfma_f32_16x16x32_bf16 v[28:31], v[62:65], v[102:105], 0
  v_mfma_f32_16x16x32_bf16 v[32:35], v[68:71], v[96:99], 0
  v_mfma_f32_16x16x32_bf16 v[36:39], v[68:71], v[102:105], 0
  s_nop 0
  v_mfma_f32_16x16x16_bf16 v[16:19], v[60:61], v[100:101], v[16:19]
  v_mfma_f32_16x16x16_bf16 v[20:23], v[60:61], v[106:107], v[20:23]
  v_mfma_f32_16x16x16_bf16 v[24:27], v[66:67], v[100:101], v[24:27]
  v_mfma_f32_16x16x16_bf16 v[28:31], v[66:67], v[106:107], v[28:31]
  v_mfma_f32_16x16x16_bf16 v[32:35], v[72:73], v[100:101], v[32:35]
  v_mfma_f32_16x16x16_bf16 v[36:39], v[72:73], v[106:107], v[36:39]
  s_nop 3
  v_permlane16_swap_b32 v16, v20
  v_permlane16_swap_b32 v17, v21
  v_permlane16_swap_b32 v18, v22
  v_permlane16_swap_b32 v19, v23
  v_permlane16_swap_b32 v24, v28
  v_permlane16_swap_b32 v25, v29
  v_permlane16_swap_b32 v26, v30
  v_permlane16_swap_b32 v27, v31
  v_permlane16_swap_b32 v32, v36
  v_permlane16_swap_b32 v33, v37
  v_max3_f32 v112, v16, v17, v18
  v_min3_f32 v114, v16, v17, v18
  v_max3_f32 v112, v112, v19, v20
  v_min3_f32 v114, v114, v19, v20
  v_max3_f32 v112, v112, v21, v22
  v_min3_f32 v114, v114, v21, v22
  v_max3_f32 v112, v112, v23, v24
  v_min3_f32 v114, v114, v23, v24
  v_max3_f32 v112, v112, v25, v26
  v_min3_f32 v114, v114, v25, v26
  v_max3_f32 v112, v112, v27, v28
  v_min3_f32 v114, v114, v27, v28
  v_max3_f32 v112, v112, v29, v30
  v_min3_f32 v114, v114, v29, v30
  v_max3_f32 v112, v112, v31, v32
  v_min3_f32 v114, v114, v31, v32
  v_max_f32 v112, v112, v33
  v_min_f32 v114, v114, v33
  v_mul_f32 v112, s92, v112
  v_mul_f32 v114, s92, v114
  v_mov_b32 v116, s92
  v_pk_fma_f32 v[76:77], v[16:17], v[116:117], v[112:113] op_sel_hi:[1,0,0] neg_lo:[0,0,1] neg_hi:[0,0,1]
  v_pk_fma_f32 v[94:95], v[16:17], v[116:117], v[114:115] op_sel_hi:[1,0,0] neg_lo:[1,0,0] neg_hi:[1,0,0]
  v_pk_fma_f32 v[78:79], v[18:19], v[116:117], v[112:113] op_sel_hi:[1,0,0] neg_lo:[0,0,1] neg_hi:[0,0,1]
  v_pk_fma_f32 v[96:97], v[18:19], v[116:117], v[114:115] op_sel_hi:[1,0,0] neg_lo:[1,0,0] neg_hi:[1,0,0]
  v_pk_fma_f32 v[80:81], v[20:21], v[116:117], v[112:113] op_sel_hi:[1,0,0] neg_lo:[0,0,1] neg_hi:[0,0,1]
  v_pk_fma_f32 v[98:99], v[20:21], v[116:117], v[114:115] op_sel_hi:[1,0,0] neg_lo:[1,0,0] neg_hi:[1,0,0]
  v_pk_fma_f32 v[82:83], v[22:23], v[116:117], v[112:113] op_sel_hi:[1,0,0] neg_lo:[0,0,1] neg_hi:[0,0,1]
  v_pk_fma_f32 v[100:101], v[22:23], v[116:117], v[114:115] op_sel_hi:[1,0,0] neg_lo:[1,0,0] neg_hi:[1,0,0]
  v_pk_fma_f32 v[84:85], v[24:25], v[116:117], v[112:113] op_sel_hi:[1,0,0] neg_lo:[0,0,1] neg_hi:[0,0,1]
  v_pk_fma_f32 v[102:103], v[24:25], v[116:117], v[114:115] op_sel_hi:[1,0,0] neg_lo:[1,0,0] neg_hi:[1,0,0]
  v_pk_fma_f32 v[86:87], v[26:27], v[116:117], v[112:113] op_sel_hi:[1,0,0] neg_lo:[0,0,1] neg_hi:[0,0,1]
  v_pk_fma_f32 v[104:105], v[26:27], v[116:117], v[114:115] op_sel_hi:[1,0,0] neg_lo:[1,0,0] neg_hi:[1,0,0]
  v_pk_fma_f32 v[88:89], v[28:29], v[116:117], v[112:113] op_sel_hi:[1,0,0] neg_lo:[0,0,1] neg_hi:[0,0,1]
  v_pk_fma_f32 v[106:107], v[28:29], v[116:117], v[114:115] op_sel_hi:[1,0,0] neg_lo:[1,0,0] neg_hi:[1,0,0]
  v_pk_fma_f32 v[90:91], v[30:31], v[116:117], v[112:113] op_sel_hi:[1,0,0] neg_lo:[0,0,1] neg_hi:[0,0,1]
  v_pk_fma_f32 v[108:109], v[30:31], v[116:117], v[114:115] op_sel_hi:[1,0,0] neg_lo:[1,0,0] neg_hi:[1,0,0]
  v_pk_fma_f32 v[92:93], v[32:33], v[116:117], v[112:113] op_sel_hi:[1,0,0] neg_lo:[0,0,1] neg_hi:[0,0,1]
  v_pk_fma_f32 v[110:111], v[32:33], v[116:117], v[114:115] op_sel_hi:[1,0,0] neg_lo:[1,0,0] neg_hi:[1,0,0]
  v_exp_f32 v76, v76
  v_exp_f32 v94, v94
  v_exp_f32 v77, v77
  v_exp_f32 v95, v95
  v_exp_f32 v78, v78
  v_exp_f32 v96, v96
  v_exp_f32 v79, v79
  v_exp_f32 v97, v97
  v_exp_f32 v80, v80
  v_exp_f32 v98, v98
  v_exp_f32 v81, v81
  v_exp_f32 v99, v99
  v_exp_f32 v82, v82
  v_exp_f32 v100, v100
  v_exp_f32 v83, v83
  v_exp_f32 v101, v101
  v_exp_f32 v84, v84
  v_exp_f32 v102, v102
  v_exp_f32 v85, v85
  v_exp_f32 v103, v103
  v_exp_f32 v86, v86
  v_exp_f32 v104, v104
  v_exp_f32 v87, v87
  v_exp_f32 v105, v105
  v_exp_f32 v88, v88
  v_exp_f32 v106, v106
  v_exp_f32 v89, v89
  v_exp_f32 v107, v107
  v_exp_f32 v90, v90
  v_exp_f32 v108, v108
  v_exp_f32 v91, v91
  v_exp_f32 v109, v109
  v_exp_f32 v92, v92
  v_exp_f32 v110, v110
  v_exp_f32 v93, v93
  v_exp_f32 v111, v111
  v_pk_add_f32 v[112:113], v[76:77], v[78:79]
  v_pk_add_f32 v[114:115], v[94:95], v[96:97]
  v_pk_add_f32 v[116:117], v[80:81], v[82:83]
  v_pk_add_f32 v[118:119], v[98:99], v[100:101]
  v_pk_add_f32 v[112:113], v[112:113], v[84:85]
  v_pk_add_f32 v[114:115], v[114:115], v[102:103]
  v_pk_add_f32 v[116:117], v[116:117], v[86:87]
  v_pk_add_f32 v[118:119], v[118:119], v[104:105]
  v_pk_add_f32 v[112:113], v[112:113], v[88:89]
  v_pk_add_f32 v[114:115], v[114:115], v[106:107]
  v_pk_add_f32 v[116:117], v[116:117], v[90:91]
  v_pk_add_f32 v[118:119], v[118:119], v[108:109]
  v_pk_add_f32 v[112:113], v[112:113], v[92:93]
  v_pk_add_f32 v[114:115], v[114:115], v[110:111]
  v_pk_add_f32 v[112:113], v[112:113], v[116:117]
  v_pk_add_f32 v[114:115], v[114:115], v[118:119]
  v_add_f32 v112, v112, v113
  v_add_f32 v114, v114, v115
  v_rcp_f32 v112, v112
  v_rcp_f32 v114, v114
  v_pk_mul_f32 v[76:77], v[76:77], v[112:113] op_sel_hi:[1,0]
  v_pk_mul_f32 v[94:95], v[94:95], v[114:115] op_sel_hi:[1,0]
  v_pk_mul_f32 v[78:79], v[78:79], v[112:113] op_sel_hi:[1,0]
  v_pk_mul_f32 v[96:97], v[96:97], v[114:115] op_sel_hi:[1,0]
  v_pk_mul_f32 v[80:81], v[80:81], v[112:113] op_sel_hi:[1,0]
  v_pk_mul_f32 v[98:99], v[98:99], v[114:115] op_sel_hi:[1,0]
  v_pk_mul_f32 v[82:83], v[82:83], v[112:113] op_sel_hi:[1,0]
  v_pk_mul_f32 v[100:101], v[100:101], v[114:115] op_sel_hi:[1,0]
  v_pk_mul_f32 v[84:85], v[84:85], v[112:113] op_sel_hi:[1,0]
  v_pk_mul_f32 v[102:103], v[102:103], v[114:115] op_sel_hi:[1,0]
  v_pk_mul_f32 v[86:87], v[86:87], v[112:113] op_sel_hi:[1,0]
  v_pk_mul_f32 v[104:105], v[104:105], v[114:115] op_sel_hi:[1,0]
  v_pk_mul_f32 v[88:89], v[88:89], v[112:113] op_sel_hi:[1,0]
  v_pk_mul_f32 v[106:107], v[106:107], v[114:115] op_sel_hi:[1,0]
  v_pk_mul_f32 v[90:91], v[90:91], v[112:113] op_sel_hi:[1,0]
  v_pk_mul_f32 v[108:109], v[108:109], v[114:115] op_sel_hi:[1,0]
  v_pk_mul_f32 v[92:93], v[92:93], v[112:113] op_sel_hi:[1,0]
  v_pk_mul_f32 v[110:111], v[110:111], v[114:115] op_sel_hi:[1,0]
  v_cvt_pk_bf16_f32 v16, v76, v77
  v_cvt_pk_bf16_f32 v17, v78, v79
  v_cvt_pk_bf16_f32 v18, v80, v81
  v_cvt_pk_bf16_f32 v19, v82, v83
  v_cvt_pk_bf16_f32 v20, v84, v85
  v_cvt_pk_bf16_f32 v21, v86, v87
  v_cvt_pk_bf16_f32 v22, v88, v89
  v_cvt_pk_bf16_f32 v23, v90, v91
  v_cvt_pk_bf16_f32 v24, v92, v93
  v_cvt_pk_bf16_f32 v25, v94, v95
  v_cvt_pk_bf16_f32 v26, v96, v97
  v_cvt_pk_bf16_f32 v27, v98, v99
  v_cvt_pk_bf16_f32 v28, v100, v101
  v_cvt_pk_bf16_f32 v29, v102, v103
  v_cvt_pk_bf16_f32 v30, v104, v105
  v_cvt_pk_bf16_f32 v31, v106, v107
  v_cvt_pk_bf16_f32 v32, v108, v109
  v_cvt_pk_bf16_f32 v33, v110, v111
  v_mov_b32 v34, 0
  v_mov_b32 v35, 0
  v_lshrrev_b32 v12, 1, v11
  v_mul_u32_u24 v12, 19, v12
  v_and_b32 v13, 3, v10
  v_add_u32 v12, v12, v13
  v_mul_u32_u24 v12, 80, v12
  v_add_u32 v36, 10240, v12
  v_mov_b32 v13, 163812
  s_mov_b32 s93, 0
L_lw_39:
  ds_read_b32 v14, v13
  s_add_u32 s93, s93, 1
  s_waitcnt lgkmcnt(0)
  v_readfirstlane_b32 s57, v14
  s_cmp_gt_u32 s93, 40000
  s_cbranch_scc1 L_lwd_40
  s_cmp_lt_u32 s57, 4
  s_cbranch_scc1 L_lw_39
L_lwd_40:
  s_mov_b32 exec_lo, 0x00f0000f
  s_mov_b32 exec_hi, 0xf0000f00
  ds_read_b128 v[204:207], v36 offset:0
  ds_read_b128 v[208:211], v36 offset:16
  ds_read_b128 v[212:215], v36 offset:32
  ds_read_b128 v[216:219], v36 offset:48
  ds_read_b128 v[220:223], v36 offset:64
  s_mov_b64 exec, -1
  s_mov_b32 exec_lo, 0x00f0000f
  s_mov_b32 exec_hi, 0xf0000f00
  ds_read_b128 v[224:227], v36 offset:320
  ds_read_b128 v[228:231], v36 offset:336
  ds_read_b128 v[232:235], v36 offset:352
  ds_read_b128 v[236:239], v36 offset:368
  ds_read_b128 v[240:243], v36 offset:384
  s_mov_b64 exec, -1
  s_waitcnt lgkmcnt(5)
  v_mfma_f32_16x16x32_bf16 v[76:79], v[204:207], v[16:19], 0
  v_mfma_f32_16x16x32_bf16 v[76:79], v[208:211], v[20:23], v[76:79]
  v_mfma_f32_16x16x32_bf16 v[76:79], v[212:215], v[24:27], v[76:79]
  v_mfma_f32_16x16x32_bf16 v[76:79], v[216:219], v[28:31], v[76:79]
  v_mfma_f32_16x16x32_bf16 v[76:79], v[220:223], v[32:35], v[76:79]
  s_mov_b32 exec_lo, 0x00f0000f
  s_mov_b32 exec_hi, 0xf0000f00
  ds_read_b128 v[204:207], v36 offset:640
  ds_read_b128 v[208:211], v36 offset:656
  ds_read_b128 v[212:215], v36 offset:672
  ds_read_b128 v[216:219], v36 offset:688
  ds_read_b128 v[220:223], v36 offset:704
  s_mov_b64 exec, -1
  s_waitcnt lgkmcnt(5)
  v_mfma_f32_16x16x32_bf16 v[80:83], v[224:227], v[16:19], 0
  v_mfma_f32_16x16x32_bf16 v[80:83], v[228:231], v[20:23], v[80:83]
  v_mfma_f32_16x16x32_bf16 v[80:83], v[232:235], v[24:27], v[80:83]
  v_mfma_f32_16x16x32_bf16 v[80:83], v[236:239], v[28:31], v[80:83]
  v_mfma_f32_16x16x32_bf16 v[80:83], v[240:243], v[32:35], v[80:83]
  s_mov_b32 exec_lo, 0x00f0000f
  s_mov_b32 exec_hi, 0xf0000f00
  ds_read_b128 v[224:227], v36 offset:960
  ds_read_b128 v[228:231], v36 offset:976
  ds_read_b128 v[232:235], v36 offset:992
  ds_read_b128 v[236:239], v36 offset:1008
  ds_read_b128 v[240:243], v36 offset:1024
  s_mov_b64 exec, -1
  s_waitcnt lgkmcnt(5)
  v_mfma_f32_16x16x32_bf16 v[84:87], v[204:207], v[16:19], 0
  v_mfma_f32_16x16x32_bf16 v[84:87], v[208:211], v[20:23], v[84:87]
  v_mfma_f32_16x16x32_bf16 v[84:87], v[212:215], v[24:27], v[84:87]
  v_mfma_f32_16x16x32_bf16 v[84:87], v[216:219], v[28:31], v[84:87]
  v_mfma_f32_16x16x32_bf16 v[84:87], v[220:223], v[32:35], v[84:87]
  s_mov_b32 exec_lo, 0x00f0000f
  s_mov_b32 exec_hi, 0xf0000f00
  ds_read_b128 v[204:207], v36 offset:1280
  ds_read_b128 v[208:211], v36 offset:1296
  ds_read_b128 v[212:215], v36 offset:1312
  ds_read_b128 v[216:219], v36 offset:1328
  ds_read_b128 v[220:223], v36 offset:1344
  s_mov_b64 exec, -1
  s_waitcnt lgkmcnt(5)
  v_mfma_f32_16x16x32_bf16 v[88:91], v[224:227], v[16:19], 0
  v_mfma_f32_16x16x32_bf16 v[88:91], v[228:231], v[20:23], v[88:91]
  v_mfma_f32_16x16x32_bf16 v[88:91], v[232:235], v[24:27], v[88:91]
  v_mfma_f32_16x16x32_bf16 v[88:91], v[236:239], v[28:31], v[88:91]
  v_mfma_f32_16x16x32_bf16 v[88:91], v[240:243], v[32:35], v[88:91]
  s_waitcnt lgkmcnt(0)
  v_mfma_f32_16x16x32_bf16 v[92:95], v[204:207], v[16:19], 0
  v_mfma_f32_16x16x32_bf16 v[92:95], v[208:211], v[20:23], v[92:95]
  v_mfma_f32_16x16x32_bf16 v[92:95], v[212:215], v[24:27], v[92:95]
  v_mfma_f32_16x16x32_bf16 v[92:95], v[216:219], v[28:31], v[92:95]
  v_mfma_f32_16x16x32_bf16 v[92:95], v[220:223], v[32:35], v[92:95]
  s_lshl_b32 s57, s50, 3
  s_lshl_b32 s58, s49, 1
  s_add_u32 s57, s57, s58
  s_mul_i32 s57, s57, 18432
  s_add_u32 s57, s57, 786432
  s_lshl_b32 s58, s51, 10
  s_add_u32 s58, s58, s57
  v_and_b32 v12, 1, v11
  v_mul_u32_u24 v12, 18432, v12
  v_lshrrev_b32 v13, 1, v11
  v_lshlrev_b32 v13, 9, v13
  v_lshl_add_u32 v13, v10, 4, v13
  v_add_u32 v13, v12, v13
  v_add_f32 v94, 0x358637bd, v94
  v_rcp_f32 v94, v94
  s_nop 0
  v_pk_mul_f32 v[76:77], v[76:77], v[94:95] op_sel_hi:[1,0]
  v_pk_mul_f32 v[78:79], v[78:79], v[94:95] op_sel_hi:[1,0]
  v_pk_mul_f32 v[80:81], v[80:81], v[94:95] op_sel_hi:[1,0]
  v_pk_mul_f32 v[82:83], v[82:83], v[94:95] op_sel_hi:[1,0]
  v_pk_mul_f32 v[84:85], v[84:85], v[94:95] op_sel_hi:[1,0]
  v_pk_mul_f32 v[86:87], v[86:87], v[94:95] op_sel_hi:[1,0]
  v_pk_mul_f32 v[88:89], v[88:89], v[94:95] op_sel_hi:[1,0]
  v_pk_mul_f32 v[90:91], v[90:91], v[94:95] op_sel_hi:[1,0]
  v_pk_mul_f32 v[92:93], v[92:93], v[94:95] op_sel_hi:[1,0]
  v_cvt_pk_bf16_f32 v100, v76, v77
  v_cvt_pk_bf16_f32 v101, v78, v79
  v_cvt_pk_bf16_f32 v102, v80, v81
  v_cvt_pk_bf16_f32 v103, v82, v83
  v_cvt_pk_bf16_f32 v104, v84, v85
  v_cvt_pk_bf16_f32 v105, v86, v87
  v_cvt_pk_bf16_f32 v106, v88, v89
  v_cvt_pk_bf16_f32 v107, v90, v91
  v_cvt_pk_bf16_f32 v108, v92, v93
  v_mov_b32 v110, v108
  v_mov_b32 v109, 0
  s_nop 1
  v_permlane32_swap_b32 v109, v110
  v_cmp_lt_u32 vcc, 31, v1
  s_nop 1
  v_cndmask_b32 v16, v100, v109, vcc
  v_cndmask_b32 v17, v101, v100, vcc
  v_cndmask_b32 v18, v102, v101, vcc
  v_cndmask_b32 v19, v103, v102, vcc
  v_cndmask_b32 v20, v104, v103, vcc
  v_cndmask_b32 v21, v105, v104, vcc
  v_cndmask_b32 v22, v106, v105, vcc
  v_cndmask_b32 v23, v107, v106, vcc
  buffer_store_dwordx4 v[16:19], v13, s[12:15], s58 offen sc1
  buffer_store_dwordx4 v[20:23], v13, s[12:15], s58 offen offset:256 sc1
  s_lshl_b32 s58, s51, 7
  s_add_u32 s58, s58, s57
  s_add_u32 s58, s58, 16384
  v_lshl_add_u32 v13, v10, 3, v12
  v_mov_b32 v24, v107
  v_mov_b32 v25, v108
  s_mov_b32 exec_lo, 0
  buffer_store_dwordx2 v[24:25], v13, s[12:15], s58 offen sc1
  s_mov_b32 exec_lo, -1
  v_mov_b32 v12, 163816
  s_mov_b32 s93, 0
L_lw_41:
  ds_read_b32 v13, v12
  s_add_u32 s93, s93, 1
  s_waitcnt lgkmcnt(0)
  v_readfirstlane_b32 s57, v13
  s_cmp_gt_u32 s93, 40000
  s_cbranch_scc1 L_lwd_42
  s_cmp_lt_u32 s57, 4
  s_cbranch_scc1 L_lw_41
L_lwd_42:
  v_mul_u32_u24 v28, 288, v75
  v_and_b32 v29, 3, v1
  v_lshl_add_u32 v28, v29, 3, v28
  v_add_u32 v29, 13568, v28
  s_lshl_b32 s57, s48, 5
  s_add_u32 s57, s57, 13312
  v_add_u32 v28, s57, v28
  v_add_u32 v30, 64512, v28
  v_add_u32 v31, 64512, v29
  ds_read_b64_tr_b16 v[120:121], v28 offset:0
  ds_read_b64_tr_b16 v[122:123], v28 offset:2304
  ds_read_b64_tr_b16 v[124:125], v28 offset:9216
  ds_read_b64_tr_b16 v[126:127], v28 offset:11520
  ds_read_b64_tr_b16 v[128:129], v28 offset:18432
  ds_read_b64_tr_b16 v[130:131], v28 offset:20736
  s_waitcnt lgkmcnt(6)
  ds_read_b64_tr_b16 v[132:133], v28 offset:27648
  ds_read_b64_tr_b16 v[134:135], v28 offset:29952
  ds_read_b64_tr_b16 v[136:137], v28 offset:36864
  ds_read_b64_tr_b16 v[138:139], v28 offset:39168
  ds_read_b64_tr_b16 v[140:141], v28 offset:46080
  ds_read_b64_tr_b16 v[142:143], v28 offset:48384
  s_waitcnt lgkmcnt(6)
  ds_read_b64_tr_b16 v[144:145], v28 offset:55296
  ds_read_b64_tr_b16 v[146:147], v28 offset:57600
  s_cmp_eq_u32 s48, 0
  s_cbranch_scc0 L_r9_43
  ds_read_b64_tr_b16 v[192:193], v29 offset:0
  ds_read_b64_tr_b16 v[194:195], v29 offset:2304
L_r9_43:
  s_cmp_eq_u32 s48, 1
  s_cbranch_scc0 L_r9_44
  ds_read_b64_tr_b16 v[192:193], v29 offset:9216
  ds_read_b64_tr_b16 v[194:195], v29 offset:11520
L_r9_44:
  s_cmp_eq_u32 s48, 2
  s_cbranch_scc0 L_r9_45
  ds_read_b64_tr_b16 v[192:193], v29 offset:18432
  ds_read_b64_tr_b16 v[194:195], v29 offset:20736
L_r9_45:
  s_cmp_eq_u32 s48, 3
  s_cbranch_scc0 L_r9_46
  ds_read_b64_tr_b16 v[192:193], v29 offset:27648
  ds_read_b64_tr_b16 v[194:195], v29 offset:29952
L_r9_46:
  s_cmp_eq_u32 s48, 4
  s_cbranch_scc0 L_r9_47
  ds_read_b64_tr_b16 v[192:193], v29 offset:36864
  ds_read_b64_tr_b16 v[194:195], v29 offset:39168
L_r9_47:
  s_cmp_eq_u32 s48, 5
  s_cbranch_scc0 L_r9_48
  ds_read_b64_tr_b16 v[192:193], v29 offset:46080
  ds_read_b64_tr_b16 v[194:195], v29 offset:48384
L_r9_48:
  s_cmp_eq_u32 s48, 6
  s_cbranch_scc0 L_r9_49
  ds_read_b64_tr_b16 v[192:193], v29 offset:55296
  ds_read_b64_tr_b16 v[194:195], v29 offset:57600
L_r9_49:
  s_waitcnt lgkmcnt(0)
  v_mov_b32 v12, 163820
  v_mov_b32 v13, 1
  s_mov_b64 exec, 1
  ds_add_u32 v12, v13
  s_mov_b64 exec, -1
  s_waitcnt vmcnt(0)
  s_mul_i32 s58, s52, 36864
  s_add_u32 s58, s58, 786432
  s_lshl_b32 s59, s49, 10
  s_add_u32 s58, s58, s59
  v_lshlrev_b32 v12, 4, v1
  s_mov_b32 s93, 0
L_pl_50:
  buffer_load_dwordx4 v[76:79], v12, s[12:15], s58 offen sc1
  s_add_u32 s59, s58, 4096
  buffer_load_dwordx4 v[80:83], v12, s[12:15], s59 offen sc1
  s_add_u32 s59, s58, 8192
  buffer_load_dwordx4 v[84:87], v12, s[12:15], s59 offen sc1
  s_add_u32 s59, s58, 12288
  buffer_load_dwordx4 v[88:91], v12, s[12:15], s59 offen sc1
  s_add_u32 s59, s58, 16384
  buffer_load_dwordx4 v[92:95], v12, s[12:15], s59 offen sc1
  s_add_u32 s59, s58, 20480
  buffer_load_dwordx4 v[96:99], v12, s[12:15], s59 offen sc1
  s_add_u32 s59, s58, 24576
  buffer_load_dwordx4 v[100:103], v12, s[12:15], s59 offen sc1
  s_add_u32 s59, s58, 28672
  buffer_load_dwordx4 v[104:107], v12, s[12:15], s59 offen sc1
  s_add_u32 s59, s58, 32768
  buffer_load_dwordx4 v[108:111], v12, s[12:15], s59 offen sc1
  s_add_u32 s93, s93, 1
  s_waitcnt vmcnt(0)
  v_max3_u32 v13, v76, v77, v78
  v_max3_u32 v13, v13, v79, v80
  v_max3_u32 v13, v13, v81, v82
  v_max3_u32 v13, v13, v83, v84
  v_max3_u32 v13, v13, v85, v86
  v_max3_u32 v13, v13, v87, v88
  v_max3_u32 v13, v13, v89, v90
  v_max3_u32 v13, v13, v91, v92
  v_max3_u32 v13, v13, v93, v94
  v_max3_u32 v13, v13, v95, v96
  v_max3_u32 v13, v13, v97, v98
  v_max3_u32 v13, v13, v99, v100
  v_max3_u32 v13, v13, v101, v102
  v_max3_u32 v13, v13, v103, v104
  v_max3_u32 v13, v13, v105, v106
  v_max3_u32 v13, v13, v107, v108
  v_max3_u32 v13, v13, v109, v110
  v_max_u32 v13, v13, v111
  v_cmp_eq_u32 vcc, -1, v13
  s_cbranch_vccz L_pld_51
  s_cmp_gt_u32 s93, 10000
  s_cbranch_scc1 L_pld_51
  s_sleep 1
  s_branch L_pl_50
L_pld_51:
  s_lshl_b32 s59, s49, 10
  v_add_u32 v13, s59, v12
  v_add_u32 v13, 114688, v13
  ds_write_b128 v13, v[76:79] offset:0
  ds_write_b128 v13, v[80:83] offset:4096
  ds_write_b128 v13, v[84:87] offset:8192
  ds_write_b128 v13, v[88:91] offset:12288
  ds_write_b128 v13, v[92:95] offset:16384
  ds_write_b128 v13, v[96:99] offset:20480
  ds_write_b128 v13, v[100:103] offset:24576
  ds_write_b128 v13, v[104:107] offset:28672
  ds_write_b128 v13, v[108:111] offset:32768
L_B2:
  s_waitcnt lgkmcnt(0)
  s_barrier
  v_mul_u32_u24 v16, 288, v75
  v_and_b32 v17, 3, v1
  v_lshl_add_u32 v16, v17, 3, v16
  v_add_u32 v17, 13568, v16
  s_lshl_b32 s57, s48, 5
  s_add_u32 s57, s57, 13312
  v_add_u32 v16, s57, v16
  v_add_u32 v18, 64512, v16
  v_add_u32 v19, 64512, v17
  ds_read_b64_tr_b16 v[148:149], v16 offset:0
  ds_read_b64_tr_b16 v[150:151], v16 offset:2304
  ds_read_b64_tr_b16 v[152:153], v16 offset:9216
  ds_read_b64_tr_b16 v[154:155], v16 offset:11520
  ds_read_b64_tr_b16 v[156:157], v16 offset:18432
  ds_read_b64_tr_b16 v[158:159], v16 offset:20736
  s_waitcnt lgkmcnt(6)
  ds_read_b64_tr_b16 v[160:161], v16 offset:27648
  ds_read_b64_tr_b16 v[162:163], v16 offset:29952
  ds_read_b64_tr_b16 v[164:165], v16 offset:36864
  ds_read_b64_tr_b16 v[166:167], v16 offset:39168
  ds_read_b64_tr_b16 v[168:169], v16 offset:46080
  ds_read_b64_tr_b16 v[170:171], v16 offset:48384
  s_waitcnt lgkmcnt(6)
  ds_read_b64_tr_b16 v[172:173], v16 offset:55296
  ds_read_b64_tr_b16 v[174:175], v16 offset:57600
  ds_read_b64_tr_b16 v[176:177], v18 offset:0
  ds_read_b64_tr_b16 v[178:179], v18 offset:2304
  ds_read_b64_tr_b16 v[180:181], v18 offset:9216
  ds_read_b64_tr_b16 v[182:183], v18 offset:11520
  s_waitcnt lgkmcnt(6)
  ds_read_b64_tr_b16 v[184:185], v18 offset:18432
  ds_read_b64_tr_b16 v[186:187], v18 offset:20736
  ds_read_b64_tr_b16 v[188:189], v18 offset:27648
  ds_read_b64_tr_b16 v[190:191], v18 offset:29952
  s_cmp_eq_u32 s48, 7
  s_cbranch_scc0 L_r9_52
  ds_read_b64_tr_b16 v[192:193], v17 offset:0
  ds_read_b64_tr_b16 v[194:195], v17 offset:2304
L_r9_52:
  s_cmp_eq_u32 s48, 0
  s_cbranch_scc0 L_r9_53
  ds_read_b64_tr_b16 v[196:197], v17 offset:9216
  ds_read_b64_tr_b16 v[198:199], v17 offset:11520
L_r9_53:
  s_cmp_eq_u32 s48, 1
  s_cbranch_scc0 L_r9_54
  ds_read_b64_tr_b16 v[196:197], v17 offset:18432
  ds_read_b64_tr_b16 v[198:199], v17 offset:20736
L_r9_54:
  s_cmp_eq_u32 s48, 2
  s_cbranch_scc0 L_r9_55
  ds_read_b64_tr_b16 v[196:197], v17 offset:27648
  ds_read_b64_tr_b16 v[198:199], v17 offset:29952
L_r9_55:
  s_cmp_eq_u32 s48, 3
  s_cbranch_scc0 L_r9_56
  ds_read_b64_tr_b16 v[196:197], v17 offset:36864
  ds_read_b64_tr_b16 v[198:199], v17 offset:39168
L_r9_56:
  s_cmp_eq_u32 s48, 4
  s_cbranch_scc0 L_r9_57
  ds_read_b64_tr_b16 v[196:197], v17 offset:46080
  ds_read_b64_tr_b16 v[198:199], v17 offset:48384
L_r9_57:
  s_cmp_eq_u32 s48, 5
  s_cbranch_scc0 L_r9_58
  ds_read_b64_tr_b16 v[196:197], v17 offset:55296
  ds_read_b64_tr_b16 v[198:199], v17 offset:57600
L_r9_58:
  s_cmp_eq_u32 s48, 6
  s_cbranch_scc0 L_r9_59
  ds_read_b64_tr_b16 v[196:197], v19 offset:0
  ds_read_b64_tr_b16 v[198:199], v19 offset:2304
L_r9_59:
  s_cmp_eq_u32 s48, 7
  s_cbranch_scc0 L_r9_60
  ds_read_b64_tr_b16 v[196:197], v19 offset:9216
  ds_read_b64_tr_b16 v[198:199], v19 offset:11520
L_r9_60:
  s_cmp_eq_u32 s48, 0
  s_cbranch_scc0 L_r9_61
  ds_read_b64_tr_b16 v[200:201], v19 offset:18432
  ds_read_b64_tr_b16 v[202:203], v19 offset:20736
L_r9_61:
  s_cmp_eq_u32 s48, 1
  s_cbranch_scc0 L_r9_62
  ds_read_b64_tr_b16 v[200:201], v19 offset:27648
  ds_read_b64_tr_b16 v[202:203], v19 offset:29952
L_r9_62:
  v_mov_b32 v220, 0
  v_dot2c_f32_bf16 v220, v212, v52
  v_dot2c_f32_bf16 v220, v213, v52
  v_dot2c_f32_bf16 v220, v214, v52
  v_dot2c_f32_bf16 v220, v215, v52
  v_dot2c_f32_bf16 v220, v216, v52
  v_dot2c_f32_bf16 v220, v217, v52
  v_dot2c_f32_bf16 v220, v218, v52
  v_dot2c_f32_bf16 v220, v219, v52
  s_nop 2
  v_add_f32_dpp v220, v220, v220 row_ror:8 row_mask:0xf bank_mask:0xf
  s_nop 1
  v_add_f32_dpp v220, v220, v220 row_ror:4 row_mask:0xf bank_mask:0xf
  s_nop 1
  v_add_f32_dpp v220, v220, v220 row_ror:2 row_mask:0xf bank_mask:0xf
  s_nop 1
  v_add_f32_dpp v220, v220, v220 row_ror:1 row_mask:0xf bank_mask:0xf
  v_mov_b32 v221, v220
  s_nop 1
  v_permlane16_swap_b32 v220, v221
  v_add_f32 v220, v220, v221
  v_mov_b32 v221, v220
  s_nop 1
  v_permlane32_swap_b32 v220, v221
  v_add_f32 v220, v220, v221
  s_cmp_ge_u32 s55, 18
  s_cbranch_scc1 L_sd_63
  s_mul_i32 s63, s54, 576
  s_lshl_b32 s57, s55, 5
  s_add_u32 s63, s63, s57
  v_lshrrev_b32 v12, 2, v1
  v_and_b32 v30, 0xfffffff3, v12
  v_and_b32 v13, 4, v12
  v_lshl_or_b32 v30, v13, 1, v30
  v_and_b32 v13, 8, v12
  v_lshrrev_b32 v13, 1, v13
  v_or_b32 v30, v30, v13
  v_mul_u32_u24 v30, 9216, v30
  v_and_b32 v13, 3, v1
  v_lshl_add_u32 v30, v13, 4, v30
  s_lshl_b32 s57, s63, 1
  v_add_u32 v30, s57, v30
  s_branch L_se_65
L_sd_63:
  v_lshrrev_b32 v12, 3, v1
  v_and_b32 v13, 3, v12
  v_lshrrev_b32 v14, 2, v12
  v_lshl_add_u32 v13, v14, 3, v13
  v_mul_u32_u24 v30, 1152, v13
  v_bfe_u32 v13, v12, 1, 2
  v_lshlrev_b32 v13, 1, v13
  v_and_b32 v14, 7, v1
  v_xor_b32 v13, v13, v14
  v_lshl_add_u32 v30, v13, 4, v30
  s_sub_u32 s63, s55, 18
  s_lshl_b32 s57, s63, 7
  v_add_u32 v30, s57, v30
L_se_65:
  v_lshlrev_b32 v21, 4, v1
  v_add_u32 v21, 114688, v21
  v_lshlrev_b32 v22, 8, v11
  v_lshl_add_u32 v22, v10, 3, v22
  v_add_u32 v22, 131072, v22
  s_lshl_b32 s60, s48, 10
  v_add_u32 v23, s60, v21
  ds_read_b128 v[76:79], v23 offset:0
  ds_read_b128 v[80:83], v23 offset:18432
  v_add_u32 v24, 8192, v23
  ds_read_b128 v[84:87], v24 offset:0
  ds_read_b128 v[88:91], v24 offset:18432
  v_add_u32 v25, s60, v22
  ds_read_b64 v[92:93], v25 offset:0
  ds_read_b64 v[94:95], v25 offset:128
  ds_read_b64 v[96:97], v25 offset:18432
  ds_read_b64 v[98:99], v25 offset:18560
  s_waitcnt lgkmcnt(0)
  s_barrier
  s_lshl_b32 s57, s52, 5
  v_add_u32 v12, s57, v10
  v_mul_u32_u24 v12, 1152, v12
  s_mul_i32 s58, s53, 288
  s_lshl_b32 s59, s48, 5
  s_add_u32 s59, s59, s58
  v_lshl_add_u32 v13, v11, 3, s59
  v_add_u32 v14, v12, v13
  buffer_load_dwordx2 v[204:205], v14, s[4:7], 0 offen
  s_mov_b32 s57, 18432
  buffer_load_dwordx2 v[206:207], v14, s[4:7], s57 offen
  buffer_load_dwordx2 v[208:209], v13, s[44:47], 0 offen
  s_lshr_b32 s59, s48, 1
  s_lshl_b32 s59, s59, 1
  s_add_u32 s59, s59, s58
  s_add_u32 s59, s59, 256
  v_lshl_add_u32 v13, v11, 3, s59
  s_and_b32 s60, s48, 1
  s_mul_i32 s60, s60, 18432
  v_add_u32 v14, v12, v13
  buffer_load_ushort v210, v14, s[4:7], s60 offen
  buffer_load_ushort v211, v13, s[44:47], 0 offen
  s_mul_i32 s57, s55, 162
  s_mul_i32 s58, s49, 41
  s_add_u32 s57, s57, s58
  v_min_u32 v12, 40, v1
  v_add_u32 v12, s57, v12
  v_min_u32 v12, 5183, v12
  v_mul_u32_u24 v13, 7282, v12
  v_lshrrev_b32 v13, 16, v13
  v_mul_u32_u24 v14, 9, v13
  v_sub_u32 v14, v12, v14
  v_mul_u32_u24 v13, 9216, v13
  v_lshl_add_u32 v13, v14, 7, v13
  s_cmp_ge_u32 s48, 4
  s_cselect_b32 s68, s28, s24
  s_cselect_b32 s69, s29, s25
  s_mov_b32 s70, 5308416
  s_mov_b32 s71, 0x20000
  s_mul_i32 s57, s54, 1152
  s_mov_b32 m0, 153600
  s_mov_b32 exec_hi, 0x1ff
  buffer_load_dword v13, s[68:71], s57 offen  lds
  s_mov_b32 exec_hi, -1
  v_mfma_f32_16x16x32_bf16 v[224:227], v[192:195], v[76:79], 0
  v_mfma_f32_16x16x32_bf16 v[228:231], v[192:195], v[80:83], 0
  v_mfma_f32_16x16x32_bf16 v[224:227], v[196:199], v[84:87], v[224:227]
  v_mfma_f32_16x16x32_bf16 v[228:231], v[196:199], v[88:91], v[228:231]
  s_cmp_lt_u32 s48, 2
  s_cbranch_scc0 L_n9_66
  v_mfma_f32_16x16x32_bf16 v[224:227], v[200:203], v[92:95], v[224:227]
  v_mfma_f32_16x16x32_bf16 v[228:231], v[200:203], v[96:99], v[228:231]
L_n9_66:
  ds_read_b128 v[100:103], v21 offset:0
  ds_read_b128 v[104:107], v21 offset:18432
  ds_read_b128 v[76:79], v21 offset:1024
  ds_read_b128 v[80:83], v21 offset:19456
  ds_read_b128 v[84:87], v21 offset:2048
  ds_read_b128 v[88:91], v21 offset:20480
  s_waitcnt lgkmcnt(4)
  v_mfma_f32_16x16x32_bf16 v[108:111], v[120:123], v[100:103], 0
  ds_read_b128 v[92:95], v21 offset:3072
  v_mfma_f32_16x16x32_bf16 v[112:115], v[120:123], v[104:107], 0
  ds_read_b128 v[96:99], v21 offset:21504
  s_waitcnt lgkmcnt(4)
  v_mfma_f32_16x16x32_bf16 v[108:111], v[124:127], v[76:79], v[108:111]
  ds_read_b128 v[100:103], v21 offset:4096
  v_mfma_f32_16x16x32_bf16 v[112:115], v[124:127], v[80:83], v[112:115]
  ds_read_b128 v[104:107], v21 offset:22528
  s_waitcnt lgkmcnt(4)
  v_mfma_f32_16x16x32_bf16 v[108:111], v[128:131], v[84:87], v[108:111]
  ds_read_b128 v[76:79], v21 offset:5120
  v_mfma_f32_16x16x32_bf16 v[112:115], v[128:131], v[88:91], v[112:115]
  ds_read_b128 v[80:83], v21 offset:23552
  s_waitcnt lgkmcnt(4)
  v_mfma_f32_16x16x32_bf16 v[108:111], v[132:135], v[92:95], v[108:111]
  ds_read_b128 v[84:87], v21 offset:6144
  v_mfma_f32_16x16x32_bf16 v[112:115], v[132:135], v[96:99], v[112:115]
  ds_read_b128 v[88:91], v21 offset:24576
  s_waitcnt lgkmcnt(4)
  v_mfma_f32_16x16x32_bf16 v[108:111], v[136:139], v[100:103], v[108:111]
  ds_read_b128 v[92:95], v21 offset:7168
  v_mfma_f32_16x16x32_bf16 v[112:115], v[136:139], v[104:107], v[112:115]
  ds_read_b128 v[96:99], v21 offset:25600
  s_lshl_b32 s57, s48, 11
  v_lshlrev_b32 v23, 4, v1
  v_add_u32 v23, s57, v23
  v_add_u32 v23, 73728, v23
  ds_write_b128 v23, v[224:227]
  ds_write_b128 v23, v[228:231] offset:1024
  s_waitcnt lgkmcnt(6)
  v_mfma_f32_16x16x32_bf16 v[108:111], v[140:143], v[76:79], v[108:111]
  ds_read_b128 v[100:103], v21 offset:8192
  v_mfma_f32_16x16x32_bf16 v[112:115], v[140:143], v[80:83], v[112:115]
  ds_read_b128 v[104:107], v21 offset:26624
  s_waitcnt lgkmcnt(6)
  v_mfma_f32_16x16x32_bf16 v[108:111], v[144:147], v[84:87], v[108:111]
  ds_read_b128 v[76:79], v21 offset:9216
  v_mfma_f32_16x16x32_bf16 v[112:115], v[144:147], v[88:91], v[112:115]
  ds_read_b128 v[80:83], v21 offset:27648
  s_waitcnt lgkmcnt(6)
  v_mfma_f32_16x16x32_bf16 v[108:111], v[148:151], v[92:95], v[108:111]
  ds_read_b128 v[84:87], v21 offset:10240
  v_mfma_f32_16x16x32_bf16 v[112:115], v[148:151], v[96:99], v[112:115]
  ds_read_b128 v[88:91], v21 offset:28672
  s_waitcnt lgkmcnt(4)
  v_mfma_f32_16x16x32_bf16 v[108:111], v[152:155], v[100:103], v[108:111]
  ds_read_b128 v[92:95], v21 offset:11264
  v_mfma_f32_16x16x32_bf16 v[112:115], v[152:155], v[104:107], v[112:115]
  ds_read_b128 v[96:99], v21 offset:29696
  s_waitcnt lgkmcnt(4)
  v_mfma_f32_16x16x32_bf16 v[108:111], v[156:159], v[76:79], v[108:111]
  ds_read_b128 v[100:103], v21 offset:12288
  v_mfma_f32_16x16x32_bf16 v[112:115], v[156:159], v[80:83], v[112:115]
  ds_read_b128 v[104:107], v21 offset:30720
  s_waitcnt lgkmcnt(4)
  v_mfma_f32_16x16x32_bf16 v[108:111], v[160:163], v[84:87], v[108:111]
  ds_read_b128 v[76:79], v21 offset:13312
  v_mfma_f32_16x16x32_bf16 v[112:115], v[160:163], v[88:91], v[112:115]
  ds_read_b128 v[80:83], v21 offset:31744
  s_waitcnt lgkmcnt(4)
  v_mfma_f32_16x16x32_bf16 v[108:111], v[164:167], v[92:95], v[108:111]
  ds_read_b128 v[84:87], v21 offset:14336
  v_mfma_f32_16x16x32_bf16 v[112:115], v[164:167], v[96:99], v[112:115]
  ds_read_b128 v[88:91], v21 offset:32768
  s_waitcnt lgkmcnt(4)
  v_mfma_f32_16x16x32_bf16 v[108:111], v[168:171], v[100:103], v[108:111]
  ds_read_b128 v[92:95], v21 offset:15360
  v_mfma_f32_16x16x32_bf16 v[112:115], v[168:171], v[104:107], v[112:115]
  ds_read_b128 v[96:99], v21 offset:33792
  s_waitcnt lgkmcnt(4)
  v_mfma_f32_16x16x32_bf16 v[108:111], v[172:175], v[76:79], v[108:111]
  ds_read_b64 v[100:101], v22 offset:0
  ds_read_b64 v[102:103], v22 offset:128
  v_mfma_f32_16x16x32_bf16 v[112:115], v[172:175], v[80:83], v[112:115]
  ds_read_b64 v[104:105], v22 offset:18432
  ds_read_b64 v[106:107], v22 offset:18560
  s_waitcnt lgkmcnt(6)
  v_mfma_f32_16x16x32_bf16 v[108:111], v[176:179], v[84:87], v[108:111]
  ds_read_b64 v[76:77], v22 offset:1024
  ds_read_b64 v[78:79], v22 offset:1152
  v_mfma_f32_16x16x32_bf16 v[112:115], v[176:179], v[88:91], v[112:115]
  ds_read_b64 v[80:81], v22 offset:19456
  ds_read_b64 v[82:83], v22 offset:19584
  s_waitcnt lgkmcnt(8)
  v_mfma_f32_16x16x32_bf16 v[108:111], v[180:183], v[92:95], v[108:111]
  v_mfma_f32_16x16x32_bf16 v[112:115], v[180:183], v[96:99], v[112:115]
  s_waitcnt lgkmcnt(4)
  v_mfma_f32_16x16x32_bf16 v[108:111], v[184:187], v[100:103], v[108:111]
  v_mfma_f32_16x16x32_bf16 v[112:115], v[184:187], v[104:107], v[112:115]
  s_waitcnt lgkmcnt(0)
  v_mfma_f32_16x16x32_bf16 v[108:111], v[188:191], v[76:79], v[108:111]
  v_mfma_f32_16x16x32_bf16 v[112:115], v[188:191], v[80:83], v[112:115]
  s_waitcnt vmcnt(1)
  s_waitcnt lgkmcnt(0)
  s_barrier
  s_and_b32 s57, s48, 1
  s_lshl_b32 s57, s57, 10
  s_lshr_b32 s58, s48, 1
  s_lshl_b32 s58, s58, 2
  s_add_u32 s57, s57, s58
  v_lshlrev_b32 v23, 4, v1
  v_add_u32 v23, s57, v23
  v_add_u32 v23, 73728, v23
  ds_read_b32 v76, v23 offset:0
  ds_read_b32 v77, v23 offset:2048
  ds_read_b32 v78, v23 offset:4096
  ds_read_b32 v79, v23 offset:6144
  ds_read_b32 v80, v23 offset:8192
  ds_read_b32 v81, v23 offset:10240
  ds_read_b32 v82, v23 offset:12288
  ds_read_b32 v83, v23 offset:14336
  v_lshlrev_b32 v12, 16, v204
  v_and_b32 v13, 0xffff0000, v204
  v_add_f32 v108, v108, v12
  v_add_f32 v109, v109, v13
  v_lshlrev_b32 v12, 16, v205
  v_and_b32 v13, 0xffff0000, v205
  v_add_f32 v110, v110, v12
  v_add_f32 v111, v111, v13
  v_lshlrev_b32 v12, 16, v206
  v_and_b32 v13, 0xffff0000, v206
  v_add_f32 v112, v112, v12
  v_add_f32 v113, v113, v13
  v_lshlrev_b32 v12, 16, v207
  v_and_b32 v13, 0xffff0000, v207
  v_add_f32 v114, v114, v12
  v_add_f32 v115, v115, v13
  v_lshlrev_b32 v84, 16, v208
  v_and_b32 v85, 0xffff0000, v208
  v_lshlrev_b32 v86, 16, v209
  v_and_b32 v87, 0xffff0000, v209
  v_lshlrev_b32 v88, 16, v211
  v_lshlrev_b32 v116, 16, v210
  v_add_f32 v90, v108, v109
  v_mul_f32 v91, v108, v108
  v_mul_f32 v92, v108, v84
  v_add_f32 v90, v90, v110
  v_fmac_f32 v91, v109, v109
  v_fmac_f32 v92, v109, v85
  v_add_f32 v90, v90, v111
  v_fmac_f32 v91, v110, v110
  v_fmac_f32 v92, v110, v86
  v_fmac_f32 v91, v111, v111
  v_fmac_f32 v92, v111, v87
  v_add_f32 v93, v112, v113
  v_mul_f32 v94, v112, v112
  v_mul_f32 v95, v112, v84
  v_add_f32 v93, v93, v114
  v_fmac_f32 v94, v113, v113
  v_fmac_f32 v95, v113, v85
  v_add_f32 v93, v93, v115
  v_fmac_f32 v94, v114, v114
  v_fmac_f32 v95, v114, v86
  v_fmac_f32 v94, v115, v115
  v_fmac_f32 v95, v115, v87
  s_waitcnt lgkmcnt(0)
  v_add_f32 v76, v76, v77
  v_add_f32 v78, v78, v79
  v_add_f32 v80, v80, v81
  v_add_f32 v82, v82, v83
  v_add_f32 v76, v76, v78
  v_add_f32 v80, v80, v82
  v_add_f32 v116, v116, v76
  v_add_f32 v116, v116, v80
  s_and_b32 s57, s48, 1
  s_cmp_eq_u32 s57, 0
  s_cselect_b32 s58, 1.0, 0
  s_cselect_b32 s59, 0, 1.0
  v_mul_f32 v12, s58, v116
  v_add_f32 v90, v90, v12
  v_fmac_f32 v91, v12, v116
  v_fmac_f32 v92, v12, v88
  v_mul_f32 v12, s59, v116
  v_add_f32 v93, v93, v12
  v_fmac_f32 v94, v12, v116
  v_fmac_f32 v95, v12, v88
  v_mov_b32 v96, 0
  v_mov_b32 v97, 0
  v_permlane16_swap_b32 v90, v91
  v_permlane16_swap_b32 v92, v96
  v_permlane16_swap_b32 v93, v94
  v_permlane16_swap_b32 v95, v97
  v_add_f32 v90, v90, v91
  v_add_f32 v92, v92, v96
  v_add_f32 v93, v93, v94
  v_add_f32 v95, v95, v97
  v_permlane32_swap_b32 v90, v92
  s_nop 0
  v_permlane32_swap_b32 v93, v95
  v_add_f32 v90, v90, v92
  v_add_f32 v93, v93, v95
  s_lshl_b32 s57, s48, 9
  v_lshlrev_b32 v12, 2, v1
  v_add_u32 v13, s57, v12
  v_add_u32 v13, 90112, v13
  ds_write_b32 v13, v90
  ds_write_b32 v13, v93 offset:256
  s_waitcnt lgkmcnt(0)
  s_barrier
  s_lshl_b32 s60, s52, 11
  s_add_u32 s60, s60, 3145728
  s_cmp_lt_u32 s48, 2
  s_cbranch_scc0 L_sp_67
  s_lshl_b32 s57, s48, 8
  v_add_u32 v13, s57, v12
  v_add_u32 v13, 90112, v13
  ds_read_b32 v76, v13 offset:0
  ds_read_b32 v77, v13 offset:512
  ds_read_b32 v78, v13 offset:1024
  ds_read_b32 v79, v13 offset:1536
  ds_read_b32 v80, v13 offset:2048
  ds_read_b32 v81, v13 offset:2560
  ds_read_b32 v82, v13 offset:3072
  ds_read_b32 v83, v13 offset:3584
  v_lshlrev_b32 v14, 4, v10
  v_lshl_add_u32 v14, v11, 2, v14
  s_lshl_b32 s59, s53, 9
  s_add_u32 s59, s59, s60
  s_add_u32 s59, s59, s57
  s_waitcnt lgkmcnt(0)
  v_add_f32 v76, v76, v77
  v_add_f32 v78, v78, v79
  v_add_f32 v80, v80, v81
  v_add_f32 v82, v82, v83
  v_add_f32 v76, v76, v78
  v_add_f32 v80, v80, v82
  v_add_f32 v76, v76, v80
  buffer_store_dword v76, v14, s[12:15], s59 offen sc1
L_sp_67:
  s_cmp_ge_u32 s48, 2
  s_cbranch_scc1 L_w27_69
  s_cmp_eq_u32 s48, 0
  s_cbranch_scc0 L_wj_70
  v_and_b32 v12, 31, v1
  v_lshlrev_b32 v12, 4, v12
  s_mov_b32 s93, 0
L_pl_71:
  buffer_load_dwordx4 v[76:79], v12, s[12:15], s60 offen offset:0 sc1
  buffer_load_dwordx4 v[80:83], v12, s[12:15], s60 offen offset:512 sc1
  buffer_load_dwordx4 v[84:87], v12, s[12:15], s60 offen offset:1024 sc1
  buffer_load_dwordx4 v[88:91], v12, s[12:15], s60 offen offset:1536 sc1
  s_add_u32 s93, s93, 1
  s_waitcnt vmcnt(0)
  v_max3_u32 v13, v76, v77, v78
  v_max3_u32 v13, v13, v80, v81
  v_max3_u32 v13, v13, v82, v84
  v_max3_u32 v13, v13, v85, v86
  v_max3_u32 v13, v13, v88, v89
  v_max_u32 v13, v13, v90
  v_cmp_eq_u32 vcc, -1, v13
  s_cbranch_vccz L_pld_72
  s_cmp_gt_u32 s93, 10000
  s_cbranch_scc1 L_pld_72
  s_sleep 1
  s_branch L_pl_71
L_pld_72:
  v_add_f32 v76, v76, v80
  v_add_f32 v84, v84, v88
  v_add_f32 v77, v77, v81
  v_add_f32 v85, v85, v89
  v_add_f32 v78, v78, v82
  v_add_f32 v86, v86, v90
  v_add_f32 v76, v76, v84
  v_add_f32 v77, v77, v85
  v_add_f32 v78, v78, v86
  v_mul_f32 v76, 0x3ae38e39, v76
  v_mul_f32 v77, 0x3ae38e39, v77
  v_fma_f32 v77, -v76, v76, v77
  v_max_f32 v77, 0, v77
  v_add_f32 v77, 0x3727c5ac, v77
  v_rsq_f32 v77, v77
  v_fma_f32 v78, -v76, v220, v78
  v_mul_f32 v78, v78, v77
  s_lshl_b32 s58, s52, 7
  s_add_u32 s59, s58, 3276800
  v_and_b32 v12, 31, v1
  v_lshlrev_b32 v13, 2, v12
  v_lshlrev_b32 v12, 3, v12
  s_mov_b32 exec_hi, 0
  buffer_store_dword v78, v13, s[12:15], s59 offen sc1
  v_add_u32 v14, 111616, v12
  ds_write_b64 v14, v[76:77]
  v_add_f32 v79, 1.0, v77
  v_rcp_f32 v79, v79
  s_nop 0
  v_mul_f32 v80, v77, v79
  v_mul_f32 v81, v76, v80
  v_sub_f32 v81, 0, v81
  s_lshl_b32 s58, s52, 8
  s_add_u32 s59, s58, 3284992
  buffer_store_dwordx2 v[80:81], v12, s[12:15], s59 offen sc1
  s_mov_b32 exec_hi, -1
  s_branch L_wj_70
L_w27_69:
L_wj_70:
  s_waitcnt lgkmcnt(0)
  s_barrier
  v_lshlrev_b32 v12, 3, v10
  v_add_u32 v12, 111616, v12
  ds_read_b64 v[76:77], v12
  ds_read_b64 v[82:83], v12 offset:128
  s_waitcnt lgkmcnt(0)
  v_sub_f32 v90, v108, v76
  v_sub_f32 v91, v109, v76
  v_sub_f32 v92, v110, v76
  v_sub_f32 v93, v111, v76
  v_fma_f32 v108, v90, v77, v108
  v_fma_f32 v109, v91, v77, v109
  v_fma_f32 v110, v92, v77, v110
  v_fma_f32 v111, v93, v77, v111
  v_cvt_pk_bf16_f32 v84, v108, v109
  v_cvt_pk_bf16_f32 v85, v110, v111
  v_sub_f32 v90, v112, v82
  v_sub_f32 v91, v113, v82
  v_sub_f32 v92, v114, v82
  v_sub_f32 v93, v115, v82
  v_fma_f32 v112, v90, v83, v112
  v_fma_f32 v113, v91, v83, v113
  v_fma_f32 v114, v92, v83, v114
  v_fma_f32 v115, v93, v83, v115
  v_cvt_pk_bf16_f32 v86, v112, v113
  v_cvt_pk_bf16_f32 v87, v114, v115
  s_and_b32 s57, s48, 1
  s_cmp_eq_u32 s57, 0
  s_cselect_b64 vcc, -1, 0
  s_nop 1
  v_cndmask_b32 v12, v82, v76, vcc
  v_cndmask_b32 v13, v83, v77, vcc
  v_sub_f32 v12, v116, v12
  v_fma_f32 v116, v12, v13, v116
  v_cvt_pk_bf16_f32 v116, v116, v116
  v_mul_u32_u24 v12, 288, v10
  v_lshl_add_u32 v12, v11, 3, v12
  v_add_u32 v12, 94208, v12
  s_lshl_b32 s58, s48, 5
  v_add_u32 v13, s58, v12
  ds_write_b64 v13, v[84:85]
  ds_write_b64 v13, v[86:87] offset:4608
  s_mul_i32 s57, s57, 4608
  s_lshr_b32 s58, s48, 1
  s_lshl_b32 s58, s58, 1
  s_add_u32 s57, s57, s58
  s_add_u32 s57, s57, 256
  v_add_u32 v13, s57, v12
  ds_write_b16 v13, v116
  s_waitcnt lgkmcnt(0)
  s_barrier
  v_add_u32 v12, 0, v1
  v_mul_u32_u24 v13, 3641, v12
  v_lshrrev_b32 v13, 16, v13
  v_mul_u32_u24 v14, 18, v13
  v_sub_u32 v14, v12, v14
  s_lshl_b32 s57, s48, 2
  v_add_u32 v13, s57, v13
  v_mul_u32_u24 v15, 288, v13
  v_lshl_add_u32 v15, v14, 4, v15
  v_add_u32 v15, 94208, v15
  ds_read_b128 v[76:79], v15
  s_lshl_b32 s57, s52, 5
  v_add_u32 v13, s57, v13
  v_mul_u32_u24 v13, 1152, v13
  v_lshl_add_u32 v16, v14, 4, v13
  v_add_u32 v12, 64, v1
  v_mul_u32_u24 v13, 3641, v12
  v_lshrrev_b32 v13, 16, v13
  v_mul_u32_u24 v14, 18, v13
  v_sub_u32 v14, v12, v14
  s_lshl_b32 s57, s48, 2
  v_add_u32 v13, s57, v13
  v_mul_u32_u24 v15, 288, v13
  v_lshl_add_u32 v15, v14, 4, v15
  v_add_u32 v15, 94208, v15
  ds_read_b128 v[80:83], v15
  s_lshl_b32 s57, s52, 5
  v_add_u32 v13, s57, v13
  v_mul_u32_u24 v13, 1152, v13
  v_lshl_add_u32 v17, v14, 4, v13
  s_mul_i32 s57, s53, 288
  s_waitcnt lgkmcnt(1)
  buffer_store_dwordx4 v[76:79], v16, s[16:19], s57 offen sc1
  s_mov_b32 exec_lo, 0xff
  s_mov_b32 exec_hi, 0
  s_waitcnt lgkmcnt(0)
  buffer_store_dwordx4 v[80:83], v17, s[16:19], s57 offen sc1
  s_mov_b64 exec, -1
  s_cmp_ge_u32 s55, 27
  s_cbranch_scc1 L_S
  s_cmp_ge_u32 s55, 18
  s_cbranch_scc1 L_D
  s_cmp_ge_u32 s48, 4
  s_cselect_b32 s68, s28, s24
  s_cselect_b32 s69, s29, s25
  s_mov_b32 s70, 5308416
  s_mov_b32 s71, 0x20000
  s_cselect_b32 s72, 36864, 0
  s_mul_i32 s60, s49, 9
  s_lshl_b32 s73, s60, 10
  s_add_u32 s72, s72, s73
  s_mul_i32 s73, s60, 147456
  s_add_u32 m0, s72, 0
  s_add_u32 s74, s73, 0
  buffer_load_dwordx4 v30, s[68:71], s74 offen  lds
  s_add_u32 m0, s72, 1024
  s_add_u32 s74, s73, 147456
  buffer_load_dwordx4 v30, s[68:71], s74 offen  lds
  s_add_u32 m0, s72, 2048
  s_add_u32 s74, s73, 294912
  buffer_load_dwordx4 v30, s[68:71], s74 offen  lds
  s_add_u32 m0, s72, 3072
  s_add_u32 s74, s73, 442368
  buffer_load_dwordx4 v30, s[68:71], s74 offen  lds
  s_add_u32 m0, s72, 4096
  s_add_u32 s74, s73, 589824
  buffer_load_dwordx4 v30, s[68:71], s74 offen  lds
  s_add_u32 m0, s72, 5120
  s_add_u32 s74, s73, 737280
  buffer_load_dwordx4 v30, s[68:71], s74 offen  lds
  s_add_u32 m0, s72, 6144
  s_add_u32 s74, s73, 884736
  buffer_load_dwordx4 v30, s[68:71], s74 offen  lds
  s_add_u32 m0, s72, 7168
  s_add_u32 s74, s73, 1032192
  buffer_load_dwordx4 v30, s[68:71], s74 offen  lds
  s_add_u32 m0, s72, 8192
  s_add_u32 s74, s73, 1179648
  buffer_load_dwordx4 v30, s[68:71], s74 offen  lds
  s_lshr_b32 s58, s48, 2
  s_lshr_b32 s59, s49, 1
  s_mul_i32 s59, s59, 36864
  s_and_b32 s57, s49, 1
  s_lshl_b32 s57, s57, 5
  s_add_u32 s59, s59, s57
  s_mul_i32 s57, s58, 18432
  s_add_u32 s59, s59, s57
  v_lshlrev_b32 v16, 6, v75
  v_and_b32 v13, 3, v1
  v_lshl_add_u32 v16, v13, 3, v16
  v_add_u32 v16, s59, v16
  v_and_b32 v12, 7, v10
  v_lshlrev_b32 v12, 4, v12
  v_lshl_add_u32 v12, v11, 7, v12
  s_mul_i32 s59, s54, 9216
  s_mul_i32 s58, s58, 4608
  s_add_u32 s58, s58, s59
  s_add_u32 s58, s58, 3522560
  s_waitcnt vmcnt(0)
  s_barrier
  ds_read_b64_tr_b16 v[148:149], v16 offset:0
  ds_read_b64_tr_b16 v[150:151], v16 offset:512
  ds_read_b64_tr_b16 v[152:153], v16 offset:2048
  ds_read_b64_tr_b16 v[154:155], v16 offset:2560
  ds_read_b64_tr_b16 v[156:157], v16 offset:4096
  ds_read_b64_tr_b16 v[158:159], v16 offset:4608
  ds_read_b64_tr_b16 v[160:161], v16 offset:6144
  ds_read_b64_tr_b16 v[162:163], v16 offset:6656
  ds_read_b64_tr_b16 v[164:165], v16 offset:8192
  ds_read_b64_tr_b16 v[166:167], v16 offset:8704
  ds_read_b64_tr_b16 v[168:169], v16 offset:10240
  ds_read_b64_tr_b16 v[170:171], v16 offset:10752
  ds_read_b64_tr_b16 v[172:173], v16 offset:12288
  ds_read_b64_tr_b16 v[174:175], v16 offset:12800
  ds_read_b64_tr_b16 v[176:177], v16 offset:14336
  ds_read_b64_tr_b16 v[178:179], v16 offset:14848
  ds_read_b64_tr_b16 v[180:181], v16 offset:16384
  ds_read_b64_tr_b16 v[182:183], v16 offset:16896
  s_cmp_eq_u32 s48, 0
  s_cbranch_scc0 L_lp_73
  v_min_u32 v13, 17, v1
  v_lshlrev_b32 v13, 9, v13
  v_add_u32 v13, 508, v13
  s_mul_i32 s59, s54, 9216
  s_add_u32 s59, s59, 3522560
  s_mov_b32 s93, 0
L_pl_74:
  buffer_load_dword v14, v13, s[12:15], s59 offen sc1
  s_add_u32 s93, s93, 1
  s_waitcnt vmcnt(0)
  v_cmp_eq_u32 vcc, -1, v14
  s_cbranch_vccz L_pld_75
  s_cmp_gt_u32 s93, 10000
  s_cbranch_scc1 L_pld_75
  s_sleep 1
  s_branch L_pl_74
L_pld_75:
L_lp_73:
  s_barrier
  s_mov_b32 s93, 0
L_pl_76:
  buffer_load_dwordx4 v[76:79], v12, s[12:15], s58 offen offset:0 sc1
  buffer_load_dwordx4 v[80:83], v12, s[12:15], s58 offen offset:512 sc1
  buffer_load_dwordx4 v[84:87], v12, s[12:15], s58 offen offset:1024 sc1
  buffer_load_dwordx4 v[88:91], v12, s[12:15], s58 offen offset:1536 sc1
  buffer_load_dwordx4 v[92:95], v12, s[12:15], s58 offen offset:2048 sc1
  buffer_load_dwordx4 v[96:99], v12, s[12:15], s58 offen offset:2560 sc1
  buffer_load_dwordx4 v[100:103], v12, s[12:15], s58 offen offset:3072 sc1
  buffer_load_dwordx4 v[104:107], v12, s[12:15], s58 offen offset:3584 sc1
  s_add_u32 s59, s58, 4096
  buffer_load_dwordx4 v[108:111], v12, s[12:15], s59 offen offset:0 sc1
  s_add_u32 s93, s93, 1
  s_waitcnt vmcnt(0)
  v_max3_u32 v13, v76, v77, v78
  v_max3_u32 v13, v13, v79, v80
  v_max3_u32 v13, v13, v81, v82
  v_max3_u32 v13, v13, v83, v84
  v_max3_u32 v13, v13, v85, v86
  v_max3_u32 v13, v13, v87, v88
  v_max3_u32 v13, v13, v89, v90
  v_max3_u32 v13, v13, v91, v92
  v_max3_u32 v13, v13, v93, v94
  v_max3_u32 v13, v13, v95, v96
  v_max3_u32 v13, v13, v97, v98
  v_max3_u32 v13, v13, v99, v100
  v_max3_u32 v13, v13, v101, v102
  v_max3_u32 v13, v13, v103, v104
  v_max3_u32 v13, v13, v105, v106
  v_max3_u32 v13, v13, v107, v108
  v_max3_u32 v13, v13, v109, v110
  v_max_u32 v13, v13, v111
  v_cmp_eq_u32 vcc, -1, v13
  s_cbranch_vccz L_pld_77
  s_cmp_gt_u32 s93, 10000
  s_cbranch_scc1 L_pld_77
  s_sleep 1
  s_branch L_pl_76
L_pld_77:
  s_waitcnt lgkmcnt(0)
  v_mfma_f32_16x16x32_bf16 v[16:19], v[148:151], v[76:79], 0
  v_mfma_f32_16x16x32_bf16 v[20:23], v[152:155], v[80:83], 0
  v_mfma_f32_16x16x32_bf16 v[16:19], v[156:159], v[84:87], v[16:19]
  v_mfma_f32_16x16x32_bf16 v[20:23], v[160:163], v[88:91], v[20:23]
  v_mfma_f32_16x16x32_bf16 v[16:19], v[164:167], v[92:95], v[16:19]
  v_mfma_f32_16x16x32_bf16 v[20:23], v[168:171], v[96:99], v[20:23]
  v_mfma_f32_16x16x32_bf16 v[16:19], v[172:175], v[100:103], v[16:19]
  v_mfma_f32_16x16x32_bf16 v[20:23], v[176:179], v[104:107], v[20:23]
  v_mfma_f32_16x16x32_bf16 v[16:19], v[180:183], v[108:111], v[16:19]
  s_nop 7
  v_add_f32 v16, v16, v20
  v_add_f32 v17, v17, v21
  v_add_f32 v18, v18, v22
  v_add_f32 v19, v19, v23
  s_lshl_b32 s57, s48, 10
  s_add_u32 s57, s57, 103424
  v_lshlrev_b32 v12, 4, v1
  v_add_u32 v12, s57, v12
  ds_write_b128 v12, v[16:19]
  s_waitcnt lgkmcnt(0)
  s_barrier
  s_cmp_ge_u32 s48, 2
  s_cbranch_scc1 L_exit
  v_lshrrev_b32 v12, 5, v0
  v_bfe_u32 v13, v0, 2, 3
  v_and_b32 v14, 3, v0
  v_lshlrev_b32 v15, 3, v12
  v_lshl_add_u32 v15, v14, 1, v15
  v_lshrrev_b32 v16, 4, v15
  v_lshlrev_b32 v16, 10, v16
  v_bfe_u32 v17, v15, 2, 2
  v_lshl_add_u32 v17, v17, 4, v13
  v_lshl_add_u32 v16, v17, 4, v16
  v_and_b32 v17, 3, v15
  v_lshl_add_u32 v16, v17, 2, v16
  v_add_u32 v16, 103424, v16
  ds_read_b64 v[20:21], v16
  ds_read_b64 v[22:23], v16 offset:4096
  ds_read_b64 v[24:25], v16 offset:2048
  ds_read_b64 v[26:27], v16 offset:6144
  s_lshl_b32 s57, s63, 4
  s_add_u32 s57, s57, 3301376
  v_lshlrev_b32 v12, 2, v0
  s_waitcnt lgkmcnt(0)
  v_add_f32 v20, v20, v22
  v_add_f32 v24, v24, v26
  v_add_f32 v21, v21, v23
  v_add_f32 v25, v25, v27
  v_mul_f32 v28, 0xbfb8aa3b, v20
  v_mul_f32 v29, 0xbfb8aa3b, v21
  v_exp_f32 v28, v28
  v_exp_f32 v29, v29
  v_add_f32 v28, 1.0, v28
  v_add_f32 v29, 1.0, v29
  v_rcp_f32 v28, v28
  v_rcp_f32 v29, v29
  v_mul_f32 v20, v20, v24
  v_mul_f32 v21, v21, v25
  v_mul_f32 v20, v20, v28
  v_mul_f32 v21, v21, v29
  v_cvt_pk_bf16_f32 v20, v20, v21
  buffer_store_dword v20, v12, s[12:15], s57 offen sc1
  s_branch L_exit
L_S:
  s_cmp_eq_u32 s55, 27
  s_cbranch_scc0 L_exit
  v_lshlrev_b32 v12, 2, v1
  v_add_u32 v12, 159744, v12
  v_mov_b32 v13, 0
  ds_write_b32 v12, v13
  ds_write_b32 v12, v13 offset:256
  s_cmp_ge_u32 s48, 2
  s_cbranch_scc1 L_rg_78
  v_lshlrev_b32 v12, 4, v1
  s_lshl_b32 s58, s48, 12
  v_add_u32 v14, s58, v12
  v_add_u32 v14, 111872, v14
  s_add_u32 s58, s58, 3276800
  s_mov_b32 s93, 0
L_pl_79:
  buffer_load_dwordx4 v[76:79], v12, s[12:15], s58 offen offset:0 sc1
  buffer_load_dwordx4 v[80:83], v12, s[12:15], s58 offen offset:1024 sc1
  buffer_load_dwordx4 v[84:87], v12, s[12:15], s58 offen offset:2048 sc1
  buffer_load_dwordx4 v[88:91], v12, s[12:15], s58 offen offset:3072 sc1
  s_add_u32 s93, s93, 1
  s_waitcnt vmcnt(0)
  v_max3_u32 v13, v76, v77, v78
  v_max3_u32 v13, v13, v79, v80
  v_max3_u32 v13, v13, v81, v82
  v_max3_u32 v13, v13, v83, v84
  v_max3_u32 v13, v13, v85, v86
  v_max3_u32 v13, v13, v87, v88
  v_max3_u32 v13, v13, v89, v90
  v_max_u32 v13, v13, v91
  v_cmp_eq_u32 vcc, -1, v13
  s_cbranch_vccz L_pld_80
  s_cmp_gt_u32 s93, 10000
  s_cbranch_scc1 L_pld_80
  s_sleep 1
  s_branch L_pl_79
L_pld_80:
  ds_write_b128 v14, v[76:79] offset:0
  ds_write_b128 v14, v[80:83] offset:1024
  ds_write_b128 v14, v[84:87] offset:2048
  ds_write_b128 v14, v[88:91] offset:3072
L_rg_78:
  s_waitcnt lgkmcnt(0)
  s_barrier
  v_lshlrev_b32 v12, 4, v0
  v_add_u32 v12, 111872, v12
  ds_read_b128 v[76:79], v12
  s_waitcnt lgkmcnt(0)
  v_lshlrev_b32 v14, 2, v0
  v_sub_u32 v14, 2047, v14
  v_ashrrev_i32 v80, 31, v76
  v_ashrrev_i32 v81, 31, v77
  v_ashrrev_i32 v82, 31, v78
  v_ashrrev_i32 v83, 31, v79
  v_or_b32 v80, 0x80000000, v80
  v_xor_b32 v76, v76, v80
  v_subrev_u32 v80, 0, v14
  v_and_b32 v76, 0xfffff800, v76
  v_or_b32 v76, v76, v80
  v_or_b32 v81, 0x80000000, v81
  v_xor_b32 v77, v77, v81
  v_subrev_u32 v81, 1, v14
  v_and_b32 v77, 0xfffff800, v77
  v_or_b32 v77, v77, v81
  v_or_b32 v82, 0x80000000, v82
  v_xor_b32 v78, v78, v82
  v_subrev_u32 v82, 2, v14
  v_and_b32 v78, 0xfffff800, v78
  v_or_b32 v78, v78, v82
  v_or_b32 v83, 0x80000000, v83
  v_xor_b32 v79, v79, v83
  v_subrev_u32 v83, 3, v14
  v_and_b32 v79, 0xfffff800, v79
  v_or_b32 v79, v79, v83
  v_max3_u32 v81, v76, v77, v78
  v_max_u32 v81, v81, v79
  s_nop 1
  v_max_u32_dpp v81, v81, v81 row_ror:8 row_mask:0xf bank_mask:0xf
  s_nop 1
  v_max_u32_dpp v81, v81, v81 row_ror:4 row_mask:0xf bank_mask:0xf
  s_nop 1
  v_max_u32_dpp v81, v81, v81 row_ror:2 row_mask:0xf bank_mask:0xf
  s_nop 1
  v_max_u32_dpp v81, v81, v81 row_ror:1 row_mask:0xf bank_mask:0xf
  v_mov_b32 v86, v81
  s_nop 1
  v_permlane16_swap_b32 v81, v86
  v_max_u32 v81, v81, v86
  s_lshl_b32 s57, s48, 3
  v_lshrrev_b32 v15, 5, v1
  v_lshlrev_b32 v15, 2, v15
  v_add_u32 v15, s57, v15
  v_add_u32 v15, 159744, v15
  s_mov_b32 exec_lo, 1
  s_mov_b32 exec_hi, 1
  ds_write_b32 v15, v81
  s_mov_b64 exec, -1
  v_lshlrev_b32 v12, 2, v10
  v_add_u32 v12, 159744, v12
  v_lshlrev_b32 v13, 4, v11
  v_add_u32 v13, 159744, v13
  s_waitcnt lgkmcnt(0)
  s_barrier
  ds_read_b32 v80, v12
  ds_read_b128 v[88:91], v13
  v_mov_b32 v83, 0
  s_waitcnt lgkmcnt(0)
  v_cmp_gt_u32 s[66:67], v88, v80
  v_cmp_gt_u32 s[68:69], v89, v80
  v_cmp_gt_u32 s[70:71], v90, v80
  v_cmp_gt_u32 s[72:73], v91, v80
  s_nop 0
  v_addc_co_u32 v83, s[74:75], 0, v83, s[66:67]
  v_addc_co_u32 v83, s[74:75], 0, v83, s[68:69]
  v_addc_co_u32 v83, s[74:75], 0, v83, s[70:71]
  v_addc_co_u32 v83, s[74:75], 0, v83, s[72:73]
  v_mov_b32 v86, v83
  s_nop 1
  v_permlane16_swap_b32 v83, v86
  v_add_u32 v83, v83, v86
  v_mov_b32 v86, v83
  s_nop 1
  v_permlane32_swap_b32 v83, v86
  v_add_u32 v83, v83, v86
  v_cmp_eq_u32 vcc, 7, v83
  s_nop 1
  s_ff1_i32_b64 s78, vcc
  s_nop 1
  v_readlane_b32 s79, v80, s78
  s_nop 1
  v_cmp_le_u32 s[66:67], s79, v76
  v_cmp_le_u32 s[68:69], s79, v77
  v_cmp_le_u32 s[70:71], s79, v78
  v_cmp_le_u32 s[72:73], s79, v79
  s_nop 1
  s_bcnt1_i32_b64 s74, s[66:67]
  s_bcnt1_i32_b64 s75, s[68:69]
  s_bcnt1_i32_b64 s76, s[70:71]
  s_bcnt1_i32_b64 s77, s[72:73]
  s_add_u32 s75, s75, s74
  s_add_u32 s76, s76, s75
  s_add_u32 s77, s77, s76
  v_mov_b32 v15, 159808
  v_mov_b32 v13, s77
  s_mov_b64 exec, 1
  ds_add_rtn_u32 v14, v15, v13
  s_mov_b64 exec, -1
  v_mbcnt_lo_u32_b32 v88, s66, 0
  v_mbcnt_hi_u32_b32 v88, s67, v88
  v_mbcnt_lo_u32_b32 v89, s68, 0
  v_mbcnt_hi_u32_b32 v89, s69, v89
  v_mbcnt_lo_u32_b32 v90, s70, 0
  v_mbcnt_hi_u32_b32 v90, s71, v90
  v_mbcnt_lo_u32_b32 v91, s72, 0
  v_mbcnt_hi_u32_b32 v91, s73, v91
  s_waitcnt lgkmcnt(0)
  v_readfirstlane_b32 s78, v14
  s_nop 1
  v_add_u32 v88, s78, v88
  v_min_u32 v88, 63, v88
  v_lshlrev_b32 v88, 2, v88
  v_add_u32 v88, 159872, v88
  s_add_u32 s79, s78, s74
  v_add_u32 v89, s79, v89
  v_min_u32 v89, 63, v89
  v_lshlrev_b32 v89, 2, v89
  v_add_u32 v89, 159872, v89
  s_add_u32 s79, s78, s75
  v_add_u32 v90, s79, v90
  v_min_u32 v90, 63, v90
  v_lshlrev_b32 v90, 2, v90
  v_add_u32 v90, 159872, v90
  s_add_u32 s79, s78, s76
  v_add_u32 v91, s79, v91
  v_min_u32 v91, 63, v91
  v_lshlrev_b32 v91, 2, v91
  v_add_u32 v91, 159872, v91
  s_mov_b64 exec, s[66:67]
  ds_write_b32 v88, v76
  s_mov_b64 exec, s[68:69]
  ds_write_b32 v89, v77
  s_mov_b64 exec, s[70:71]
  ds_write_b32 v90, v78
  s_mov_b64 exec, s[72:73]
  ds_write_b32 v91, v79
  s_mov_b64 exec, -1
  v_and_b32 v12, 31, v1
  v_lshlrev_b32 v12, 2, v12
  v_add_u32 v12, 159872, v12
  v_lshrrev_b32 v13, 5, v1
  v_lshlrev_b32 v13, 6, v13
  v_add_u32 v13, 159872, v13
  v_mov_b32 v15, 159808
  s_waitcnt lgkmcnt(0)
  s_barrier
  ds_read_b32 v14, v15
  ds_read_b32 v82, v12
  ds_read_b128 v[88:91], v13 offset:0
  ds_read_b128 v[92:95], v13 offset:16
  ds_read_b128 v[96:99], v13 offset:32
  ds_read_b128 v[100:103], v13 offset:48
  v_mov_b32 v83, 0
  s_waitcnt lgkmcnt(5)
  v_readfirstlane_b32 s78, v14
  s_nop 0
  s_cmp_gt_u32 s78, 32
  s_cbranch_scc1 L_t8s_81
  s_waitcnt lgkmcnt(0)
  v_cmp_gt_u32 s[66:67], v88, v82
  v_cmp_gt_u32 s[68:69], v89, v82
  v_cmp_gt_u32 s[70:71], v90, v82
  v_cmp_gt_u32 s[72:73], v91, v82
  s_nop 0
  v_addc_co_u32 v83, s[74:75], 0, v83, s[66:67]
  v_addc_co_u32 v83, s[74:75], 0, v83, s[68:69]
  v_addc_co_u32 v83, s[74:75], 0, v83, s[70:71]
  v_addc_co_u32 v83, s[74:75], 0, v83, s[72:73]
  v_cmp_gt_u32 s[66:67], v92, v82
  v_cmp_gt_u32 s[68:69], v93, v82
  v_cmp_gt_u32 s[70:71], v94, v82
  v_cmp_gt_u32 s[72:73], v95, v82
  s_nop 0
  v_addc_co_u32 v83, s[74:75], 0, v83, s[66:67]
  v_addc_co_u32 v83, s[74:75], 0, v83, s[68:69]
  v_addc_co_u32 v83, s[74:75], 0, v83, s[70:71]
  v_addc_co_u32 v83, s[74:75], 0, v83, s[72:73]
  v_cmp_gt_u32 s[66:67], v96, v82
  v_cmp_gt_u32 s[68:69], v97, v82
  v_cmp_gt_u32 s[70:71], v98, v82
  v_cmp_gt_u32 s[72:73], v99, v82
  s_nop 0
  v_addc_co_u32 v83, s[74:75], 0, v83, s[66:67]
  v_addc_co_u32 v83, s[74:75], 0, v83, s[68:69]
  v_addc_co_u32 v83, s[74:75], 0, v83, s[70:71]
  v_addc_co_u32 v83, s[74:75], 0, v83, s[72:73]
  v_cmp_gt_u32 s[66:67], v100, v82
  v_cmp_gt_u32 s[68:69], v101, v82
  v_cmp_gt_u32 s[70:71], v102, v82
  v_cmp_gt_u32 s[72:73], v103, v82
  s_nop 0
  v_addc_co_u32 v83, s[74:75], 0, v83, s[66:67]
  v_addc_co_u32 v83, s[74:75], 0, v83, s[68:69]
  v_addc_co_u32 v83, s[74:75], 0, v83, s[70:71]
  v_addc_co_u32 v83, s[74:75], 0, v83, s[72:73]
  v_mov_b32 v86, v83
  s_nop 1
  v_permlane32_swap_b32 v83, v86
  v_add_u32 v83, v83, v86
  v_cmp_gt_u32 vcc, 8, v83
  v_lshlrev_b32 v13, 2, v83
  s_lshl_b32 s57, s48, 5
  s_add_u32 s57, s57, 160384
  v_add_u32 v13, s57, v13
  s_mov_b32 exec_lo, vcc_lo
  s_mov_b32 exec_hi, 0
  ds_write_b32 v13, v82
  s_mov_b64 exec, -1
  v_and_b32 v12, 7, v1
  v_lshlrev_b32 v12, 2, v12
  v_add_u32 v12, s57, v12
  s_waitcnt lgkmcnt(0)
  ds_read_b32 v87, v12
  s_waitcnt lgkmcnt(0)
  s_branch L_t8d_82
L_t8s_81:
  s_waitcnt lgkmcnt(0)
  v_lshlrev_b32 v12, 2, v1
  v_add_u32 v12, 160896, v12
  v_mov_b32 v13, 0
  s_mov_b64 exec, 0xff
  ds_write_b32 v12, v13
  s_mov_b64 exec, -1
  s_waitcnt lgkmcnt(0)
  s_barrier
  v_mov_b32 v80, -1
  v_mov_b32 v15, 160896
  s_mov_b32 s79, 0
L_t8q_83:
  v_cmp_lt_u32 vcc, v76, v80
  s_nop 1
  v_cndmask_b32 v82, 0, v76, vcc
  v_cmp_lt_u32 vcc, v77, v80
  s_nop 1
  v_cndmask_b32 v83, 0, v77, vcc
  v_cmp_lt_u32 vcc, v78, v80
  s_nop 1
  v_cndmask_b32 v84, 0, v78, vcc
  v_cmp_lt_u32 vcc, v79, v80
  s_nop 1
  v_cndmask_b32 v85, 0, v79, vcc
  v_max3_u32 v81, v82, v83, v84
  v_max_u32 v81, v81, v85
  s_nop 1
  v_max_u32_dpp v81, v81, v81 row_ror:8 row_mask:0xf bank_mask:0xf
  s_nop 1
  v_max_u32_dpp v81, v81, v81 row_ror:4 row_mask:0xf bank_mask:0xf
  s_nop 1
  v_max_u32_dpp v81, v81, v81 row_ror:2 row_mask:0xf bank_mask:0xf
  s_nop 1
  v_max_u32_dpp v81, v81, v81 row_ror:1 row_mask:0xf bank_mask:0xf
  v_mov_b32 v86, v81
  s_nop 1
  v_permlane16_swap_b32 v81, v86
  v_max_u32 v81, v81, v86
  v_mov_b32 v86, v81
  s_nop 1
  v_permlane32_swap_b32 v81, v86
  v_max_u32 v81, v81, v86
  s_mov_b64 exec, 1
  ds_max_u32 v15, v81
  s_mov_b64 exec, -1
  s_waitcnt lgkmcnt(0)
  s_barrier
  ds_read_b32 v80, v15
  v_add_u32 v15, 4, v15
  s_add_u32 s79, s79, 1
  s_cmp_lt_u32 s79, 8
  s_waitcnt lgkmcnt(0)
  s_cbranch_scc1 L_t8q_83
  v_and_b32 v12, 7, v1
  v_lshlrev_b32 v12, 2, v12
  v_add_u32 v12, 160896, v12
  ds_read_b32 v87, v12
  s_waitcnt lgkmcnt(0)
L_t8d_82:
  v_and_b32 v87, 0x7ff, v87
  v_sub_u32 v87, 2047, v87
  s_nop 0
  v_readlane_b32 s60, v87, s48
  s_nop 0
  s_mul_i32 s58, s60, 1152
  s_lshl_b32 s59, s60, 3
  s_add_u32 s59, s59, 3284992
  s_lshl_b32 s61, s60, 2
  s_add_u32 s61, s61, 3276800
  v_lshlrev_b32 v12, 4, v1
  v_mov_b32 v16, 0
  v_cmp_gt_u32 vcc, 8, v1
  v_add_u32 v14, 1024, v12
  v_mov_b32 v15, 0
  v_cndmask_b32 v14, v15, v14, vcc
  s_mov_b32 s93, 0
L_pl_84:
  buffer_load_dwordx4 v[76:79], v12, s[16:19], s58 offen sc1
  buffer_load_dwordx4 v[80:83], v14, s[16:19], s58 offen sc1
  buffer_load_dwordx2 v[84:85], v16, s[12:15], s59 offen sc1
  buffer_load_dword v86, v16, s[12:15], s61 offen sc1
  s_add_u32 s93, s93, 1
  s_waitcnt vmcnt(0)
  v_max3_u32 v15, v76, v77, v78
  v_max3_u32 v15, v15, v79, v80
  v_max3_u32 v15, v15, v81, v82
  v_max3_u32 v15, v15, v83, v84
  v_max3_u32 v15, v15, v85, v86
  v_cmp_eq_u32 vcc, -1, v15
  s_cbranch_vccz L_pld_85
  s_cmp_gt_u32 s93, 10000
  s_cbranch_scc1 L_pld_85
  s_sleep 1
  s_branch L_pl_84
L_pld_85:
  v_lshlrev_b32 v13, 16, v76
  v_and_b32 v15, 0xffff0000, v76
  v_fma_f32 v13, v13, v84, v85
  v_fma_f32 v15, v15, v84, v85
  v_cvt_pk_bf16_f32 v76, v13, v15
  v_lshlrev_b32 v13, 16, v77
  v_and_b32 v15, 0xffff0000, v77
  v_fma_f32 v13, v13, v84, v85
  v_fma_f32 v15, v15, v84, v85
  v_cvt_pk_bf16_f32 v77, v13, v15
  v_lshlrev_b32 v13, 16, v78
  v_and_b32 v15, 0xffff0000, v78
  v_fma_f32 v13, v13, v84, v85
  v_fma_f32 v15, v15, v84, v85
  v_cvt_pk_bf16_f32 v78, v13, v15
  v_lshlrev_b32 v13, 16, v79
  v_and_b32 v15, 0xffff0000, v79
  v_fma_f32 v13, v13, v84, v85
  v_fma_f32 v15, v15, v84, v85
  v_cvt_pk_bf16_f32 v79, v13, v15
  v_lshlrev_b32 v13, 16, v80
  v_and_b32 v15, 0xffff0000, v80
  v_fma_f32 v13, v13, v84, v85
  v_fma_f32 v15, v15, v84, v85
  v_cvt_pk_bf16_f32 v80, v13, v15
  v_lshlrev_b32 v13, 16, v81
  v_and_b32 v15, 0xffff0000, v81
  v_fma_f32 v13, v13, v84, v85
  v_fma_f32 v15, v15, v84, v85
  v_cvt_pk_bf16_f32 v81, v13, v15
  v_lshlrev_b32 v13, 16, v82
  v_and_b32 v15, 0xffff0000, v82
  v_fma_f32 v13, v13, v84, v85
  v_fma_f32 v15, v15, v84, v85
  v_cvt_pk_bf16_f32 v82, v13, v15
  v_lshlrev_b32 v13, 16, v83
  v_and_b32 v15, 0xffff0000, v83
  v_fma_f32 v13, v13, v84, v85
  v_fma_f32 v15, v15, v84, v85
  v_cvt_pk_bf16_f32 v83, v13, v15
  v_mul_f32 v86, 0xbfb8aa3b, v86
  v_exp_f32 v86, v86
  s_nop 0
  v_add_f32 v86, 1.0, v86
  v_rcp_f32 v87, v86
  v_mov_b32 v86, s60
  s_mul_i32 s57, s48, 1168
  s_add_u32 s57, s57, 122880
  v_lshlrev_b32 v12, 4, v1
  v_add_u32 v12, s57, v12
  ds_write_b128 v12, v[76:79]
  s_mov_b64 exec, 0xff
  ds_write_b128 v12, v[80:83] offset:1024
  s_mov_b64 exec, -1
  s_lshl_b32 s57, s54, 7
  s_lshl_b32 s58, s48, 3
  s_add_u32 s57, s57, s58
  s_add_u32 s57, s57, 3596288
  s_mov_b64 exec, 1
  buffer_store_dwordx2 v[86:87], v16, s[12:15], s57 offen sc1
  s_mov_b64 exec, -1
  v_and_b32 v13, 7, v0
  v_mul_u32_u24 v13, 1168, v13
  v_lshrrev_b32 v14, 3, v0
  v_lshl_add_u32 v13, v14, 4, v13
  v_add_u32 v13, 122880, v13
  v_lshlrev_b32 v12, 4, v0
  s_mul_i32 s57, s54, 9216
  s_add_u32 s57, s57, 3522560
  s_waitcnt lgkmcnt(0)
  s_barrier
  ds_read_b128 v[76:79], v13
  ds_read_b128 v[80:83], v13 offset:1024
  s_waitcnt lgkmcnt(1)
  buffer_store_dwordx4 v[76:79], v12, s[12:15], s57 offen sc1
  s_cmp_eq_u32 s48, 0
  s_cbranch_scc0 L_exit
  s_add_u32 s57, s57, 8192
  s_waitcnt lgkmcnt(0)
  buffer_store_dwordx4 v[80:83], v12, s[12:15], s57 offen sc1
  s_branch L_exit
L_D:
  s_mul_i32 s58, s48, 9
  s_add_u32 s58, s58, 0
  s_lshl_b32 s59, s58, 10
  s_add_u32 m0, s59, 0
  s_and_b32 s57, s58, 1
  s_lshl_b32 s57, s57, 2
  s_and_b32 s59, s58, 2
  s_lshl_b32 s59, s59, 3
  s_add_u32 s57, s57, s59
  s_lshr_b32 s59, s58, 2
  s_lshl_b32 s59, s59, 5
  s_add_u32 s57, s57, s59
  s_mul_i32 s59, s54, 576
  s_add_u32 s57, s57, s59
  s_mul_i32 s57, s57, 1152
  buffer_load_dwordx4 v30, s[32:35], s57 offen  lds
  s_mul_i32 s58, s48, 9
  s_add_u32 s58, s58, 1
  s_lshl_b32 s59, s58, 10
  s_add_u32 m0, s59, 0
  s_and_b32 s57, s58, 1
  s_lshl_b32 s57, s57, 2
  s_and_b32 s59, s58, 2
  s_lshl_b32 s59, s59, 3
  s_add_u32 s57, s57, s59
  s_lshr_b32 s59, s58, 2
  s_lshl_b32 s59, s59, 5
  s_add_u32 s57, s57, s59
  s_mul_i32 s59, s54, 576
  s_add_u32 s57, s57, s59
  s_mul_i32 s57, s57, 1152
  buffer_load_dwordx4 v30, s[32:35], s57 offen  lds
  s_mul_i32 s58, s48, 9
  s_add_u32 s58, s58, 2
  s_lshl_b32 s59, s58, 10
  s_add_u32 m0, s59, 0
  s_and_b32 s57, s58, 1
  s_lshl_b32 s57, s57, 2
  s_and_b32 s59, s58, 2
  s_lshl_b32 s59, s59, 3
  s_add_u32 s57, s57, s59
  s_lshr_b32 s59, s58, 2
  s_lshl_b32 s59, s59, 5
  s_add_u32 s57, s57, s59
  s_mul_i32 s59, s54, 576
  s_add_u32 s57, s57, s59
  s_mul_i32 s57, s57, 1152
  buffer_load_dwordx4 v30, s[32:35], s57 offen  lds
  s_mul_i32 s58, s48, 9
  s_add_u32 s58, s58, 3
  s_lshl_b32 s59, s58, 10
  s_add_u32 m0, s59, 0
  s_and_b32 s57, s58, 1
  s_lshl_b32 s57, s57, 2
  s_and_b32 s59, s58, 2
  s_lshl_b32 s59, s59, 3
  s_add_u32 s57, s57, s59
  s_lshr_b32 s59, s58, 2
  s_lshl_b32 s59, s59, 5
  s_add_u32 s57, s57, s59
  s_mul_i32 s59, s54, 576
  s_add_u32 s57, s57, s59
  s_mul_i32 s57, s57, 1152
  buffer_load_dwordx4 v30, s[32:35], s57 offen  lds
  s_mul_i32 s58, s48, 9
  s_add_u32 s58, s58, 4
  s_lshl_b32 s59, s58, 10
  s_add_u32 m0, s59, 0
  s_and_b32 s57, s58, 1
  s_lshl_b32 s57, s57, 2
  s_and_b32 s59, s58, 2
  s_lshl_b32 s59, s59, 3
  s_add_u32 s57, s57, s59
  s_lshr_b32 s59, s58, 2
  s_lshl_b32 s59, s59, 5
  s_add_u32 s57, s57, s59
  s_mul_i32 s59, s54, 576
  s_add_u32 s57, s57, s59
  s_mul_i32 s57, s57, 1152
  buffer_load_dwordx4 v30, s[32:35], s57 offen  lds
  s_mul_i32 s58, s48, 9
  s_add_u32 s58, s58, 5
  s_lshl_b32 s59, s58, 10
  s_add_u32 m0, s59, 0
  s_and_b32 s57, s58, 1
  s_lshl_b32 s57, s57, 2
  s_and_b32 s59, s58, 2
  s_lshl_b32 s59, s59, 3
  s_add_u32 s57, s57, s59
  s_lshr_b32 s59, s58, 2
  s_lshl_b32 s59, s59, 5
  s_add_u32 s57, s57, s59
  s_mul_i32 s59, s54, 576
  s_add_u32 s57, s57, s59
  s_mul_i32 s57, s57, 1152
  buffer_load_dwordx4 v30, s[32:35], s57 offen  lds
  s_mul_i32 s58, s48, 9
  s_add_u32 s58, s58, 6
  s_lshl_b32 s59, s58, 10
  s_add_u32 m0, s59, 0
  s_and_b32 s57, s58, 1
  s_lshl_b32 s57, s57, 2
  s_and_b32 s59, s58, 2
  s_lshl_b32 s59, s59, 3
  s_add_u32 s57, s57, s59
  s_lshr_b32 s59, s58, 2
  s_lshl_b32 s59, s59, 5
  s_add_u32 s57, s57, s59
  s_mul_i32 s59, s54, 576
  s_add_u32 s57, s57, s59
  s_mul_i32 s57, s57, 1152
  buffer_load_dwordx4 v30, s[32:35], s57 offen  lds
  s_mul_i32 s58, s48, 9
  s_add_u32 s58, s58, 7
  s_lshl_b32 s59, s58, 10
  s_add_u32 m0, s59, 0
  s_and_b32 s57, s58, 1
  s_lshl_b32 s57, s57, 2
  s_and_b32 s59, s58, 2
  s_lshl_b32 s59, s59, 3
  s_add_u32 s57, s57, s59
  s_lshr_b32 s59, s58, 2
  s_lshl_b32 s59, s59, 5
  s_add_u32 s57, s57, s59
  s_mul_i32 s59, s54, 576
  s_add_u32 s57, s57, s59
  s_mul_i32 s57, s57, 1152
  buffer_load_dwordx4 v30, s[32:35], s57 offen  lds
  s_mul_i32 s58, s48, 9
  s_add_u32 s58, s58, 8
  s_lshl_b32 s59, s58, 10
  s_add_u32 m0, s59, 0
  s_and_b32 s57, s58, 1
  s_lshl_b32 s57, s57, 2
  s_and_b32 s59, s58, 2
  s_lshl_b32 s59, s59, 3
  s_add_u32 s57, s57, s59
  s_lshr_b32 s59, s58, 2
  s_lshl_b32 s59, s59, 5
  s_add_u32 s57, s57, s59
  s_mul_i32 s59, s54, 576
  s_add_u32 s57, s57, s59
  s_mul_i32 s57, s57, 1152
  buffer_load_dwordx4 v30, s[32:35], s57 offen  lds
  s_and_b32 s61, s63, 7
  s_cmp_eq_u32 s61, s54
  s_cselect_b32 s61, 1, 0
  s_lshr_b32 s58, s48, 2
  v_bfe_u32 v13, v75, 1, 2
  v_xor_b32 v13, s49, v13
  v_lshlrev_b32 v13, 5, v13
  v_lshlrev_b32 v12, 7, v75
  v_add_u32 v12, v12, v13
  v_and_b32 v13, 3, v1
  v_lshl_add_u32 v12, v13, 3, v12
  s_mul_i32 s57, s58, 36864
  v_add_u32 v12, s57, v12
  s_waitcnt vmcnt(0)
  s_barrier
  ds_read_b64_tr_b16 v[148:149], v12 offset:0
  ds_read_b64_tr_b16 v[150:151], v12 offset:1024
  ds_read_b64_tr_b16 v[152:153], v12 offset:4096
  ds_read_b64_tr_b16 v[154:155], v12 offset:5120
  ds_read_b64_tr_b16 v[156:157], v12 offset:8192
  ds_read_b64_tr_b16 v[158:159], v12 offset:9216
  ds_read_b64_tr_b16 v[160:161], v12 offset:12288
  ds_read_b64_tr_b16 v[162:163], v12 offset:13312
  ds_read_b64_tr_b16 v[164:165], v12 offset:16384
  ds_read_b64_tr_b16 v[166:167], v12 offset:17408
  ds_read_b64_tr_b16 v[168:169], v12 offset:20480
  ds_read_b64_tr_b16 v[170:171], v12 offset:21504
  ds_read_b64_tr_b16 v[172:173], v12 offset:24576
  ds_read_b64_tr_b16 v[174:175], v12 offset:25600
  ds_read_b64_tr_b16 v[176:177], v12 offset:28672
  ds_read_b64_tr_b16 v[178:179], v12 offset:29696
  ds_read_b64_tr_b16 v[180:181], v12 offset:32768
  ds_read_b64_tr_b16 v[182:183], v12 offset:33792
  s_cmp_eq_u32 s61, 0
  s_cbranch_scc1 L_nf_86
  s_lshl_b32 s57, s54, 7
  s_lshl_b32 s59, s48, 3
  s_add_u32 s57, s57, s59
  s_add_u32 s59, s57, 3596288
  v_mov_b32 v16, 0
  s_mov_b32 s93, 0
L_pl_87:
  s_sleep 2
  buffer_load_dwordx2 v[232:233], v16, s[12:15], s59 offen sc1
  s_add_u32 s93, s93, 1
  s_waitcnt vmcnt(0)
  v_max_u32 v13, v232, v233
  v_cmp_eq_u32 vcc, -1, v13
  s_cbranch_vccz L_pld_88
  s_cmp_gt_u32 s93, 10000
  s_cbranch_scc1 L_pld_88
  s_sleep 1
  s_branch L_pl_87
L_pld_88:
  v_readfirstlane_b32 s60, v232
  s_nop 0
  s_mul_i32 s60, s60, 1152
  s_lshl_b32 s59, s63, 7
  s_add_u32 s62, s60, s59
  v_and_b32 v231, 31, v1
  v_lshlrev_b32 v231, 2, v231
  s_mov_b32 s93, 0
L_pl_89:
  buffer_load_dword v232, v231, s[16:19], s62 offen sc1
  s_add_u32 s93, s93, 1
  s_waitcnt vmcnt(0)
  v_cmp_eq_u32 vcc, -1, v232
  s_cbranch_vccz L_pld_90
  s_cmp_gt_u32 s93, 10000
  s_cbranch_scc1 L_pld_90
  s_sleep 1
  s_branch L_pl_89
L_pld_90:
L_nf_86:
  v_and_b32 v12, 7, v10
  v_lshlrev_b32 v12, 4, v12
  v_lshl_add_u32 v12, v11, 7, v12
  s_lshr_b32 s58, s48, 2
  s_mul_i32 s59, s54, 18
  s_mul_i32 s58, s58, 9
  s_add_u32 s58, s58, s59
  s_lshl_b32 s58, s58, 9
  s_add_u32 s58, s58, 3301376
  s_cmp_eq_u32 s48, 0
  s_cbranch_scc0 L_lp_91
  v_min_u32 v13, 17, v1
  v_lshlrev_b32 v13, 9, v13
  v_add_u32 v13, 508, v13
  s_mul_i32 s59, s54, 9216
  s_add_u32 s59, s59, 3301376
  s_mov_b32 s93, 0
L_pl_92:
  buffer_load_dword v14, v13, s[12:15], s59 offen sc1
  s_add_u32 s93, s93, 1
  s_waitcnt vmcnt(0)
  v_cmp_eq_u32 vcc, -1, v14
  s_cbranch_vccz L_pld_93
  s_cmp_gt_u32 s93, 10000
  s_cbranch_scc1 L_pld_93
  s_sleep 1
  s_branch L_pl_92
L_pld_93:
L_lp_91:
  s_barrier
  s_mov_b32 s93, 0
L_pl_94:
  buffer_load_dwordx4 v[76:79], v12, s[12:15], s58 offen offset:0 sc1
  buffer_load_dwordx4 v[80:83], v12, s[12:15], s58 offen offset:512 sc1
  buffer_load_dwordx4 v[84:87], v12, s[12:15], s58 offen offset:1024 sc1
  buffer_load_dwordx4 v[88:91], v12, s[12:15], s58 offen offset:1536 sc1
  buffer_load_dwordx4 v[92:95], v12, s[12:15], s58 offen offset:2048 sc1
  buffer_load_dwordx4 v[96:99], v12, s[12:15], s58 offen offset:2560 sc1
  buffer_load_dwordx4 v[100:103], v12, s[12:15], s58 offen offset:3072 sc1
  buffer_load_dwordx4 v[104:107], v12, s[12:15], s58 offen offset:3584 sc1
  s_add_u32 s59, s58, 4096
  buffer_load_dwordx4 v[108:111], v12, s[12:15], s59 offen offset:0 sc1
  s_add_u32 s93, s93, 1
  s_waitcnt vmcnt(0)
  v_max3_u32 v13, v76, v77, v78
  v_max3_u32 v13, v13, v79, v80
  v_max3_u32 v13, v13, v81, v82
  v_max3_u32 v13, v13, v83, v84
  v_max3_u32 v13, v13, v85, v86
  v_max3_u32 v13, v13, v87, v88
  v_max3_u32 v13, v13, v89, v90
  v_max3_u32 v13, v13, v91, v92
  v_max3_u32 v13, v13, v93, v94
  v_max3_u32 v13, v13, v95, v96
  v_max3_u32 v13, v13, v97, v98
  v_max3_u32 v13, v13, v99, v100
  v_max3_u32 v13, v13, v101, v102
  v_max3_u32 v13, v13, v103, v104
  v_max3_u32 v13, v13, v105, v106
  v_max3_u32 v13, v13, v107, v108
  v_max3_u32 v13, v13, v109, v110
  v_max_u32 v13, v13, v111
  v_cmp_eq_u32 vcc, -1, v13
  s_cbranch_vccz L_pld_95
  s_cmp_gt_u32 s93, 10000
  s_cbranch_scc1 L_pld_95
  s_sleep 1
  s_branch L_pl_94
L_pld_95:
  s_waitcnt lgkmcnt(0)
  v_mfma_f32_16x16x32_bf16 v[16:19], v[148:151], v[76:79], 0
  v_mfma_f32_16x16x32_bf16 v[20:23], v[152:155], v[80:83], 0
  v_mfma_f32_16x16x32_bf16 v[16:19], v[156:159], v[84:87], v[16:19]
  v_mfma_f32_16x16x32_bf16 v[20:23], v[160:163], v[88:91], v[20:23]
  v_mfma_f32_16x16x32_bf16 v[16:19], v[164:167], v[92:95], v[16:19]
  v_mfma_f32_16x16x32_bf16 v[20:23], v[168:171], v[96:99], v[20:23]
  v_mfma_f32_16x16x32_bf16 v[16:19], v[172:175], v[100:103], v[16:19]
  v_mfma_f32_16x16x32_bf16 v[20:23], v[176:179], v[104:107], v[20:23]
  v_mfma_f32_16x16x32_bf16 v[16:19], v[180:183], v[108:111], v[16:19]
  s_nop 7
  v_add_f32 v16, v16, v20
  v_add_f32 v17, v17, v21
  v_add_f32 v18, v18, v22
  v_add_f32 v19, v19, v23
  s_lshl_b32 s57, s48, 10
  s_add_u32 s57, s57, 103424
  v_lshlrev_b32 v12, 4, v1
  v_add_u32 v13, s57, v12
  ds_write_b128 v13, v[16:19]
  s_waitcnt lgkmcnt(0)
  s_barrier
  s_cmp_ge_u32 s48, 4
  s_cbranch_scc1 L_yp_96
  ds_read_b128 v[20:23], v13 offset:4096
  s_waitcnt lgkmcnt(0)
  v_add_f32 v16, v16, v20
  v_add_f32 v17, v17, v21
  v_add_f32 v18, v18, v22
  v_add_f32 v19, v19, v23
  v_lshlrev_b32 v14, 4, v10
  v_lshl_add_u32 v14, v11, 7, v14
  s_lshl_b32 s57, s63, 3
  s_add_u32 s57, s57, s54
  s_lshl_b32 s57, s57, 11
  s_lshl_b32 s58, s48, 9
  s_add_u32 s57, s57, s58
  s_add_u32 s57, s57, 3375104
  s_mov_b32 exec_lo, 0x00ff00ff
  s_mov_b32 exec_hi, 0x00ff00ff
  buffer_store_dwordx4 v[16:19], v14, s[12:15], s57 offen sc1
  s_mov_b64 exec, -1
L_yp_96:
  s_cmp_eq_u32 s61, 0
  s_cbranch_scc1 L_exit
  v_and_b32 v12, 31, v1
  v_lshrrev_b32 v13, 3, v12
  v_lshlrev_b32 v13, 9, v13
  v_bfe_u32 v14, v12, 1, 2
  v_lshl_add_u32 v13, v14, 7, v13
  v_and_b32 v14, 1, v12
  v_lshl_add_u32 v13, v14, 3, v13
  s_lshl_b32 s57, s48, 4
  v_add_u32 v13, s57, v13
  v_lshrrev_b32 v14, 5, v1
  v_lshlrev_b32 v14, 13, v14
  v_add_u32 v13, v13, v14
  s_lshl_b32 s58, s63, 14
  s_add_u32 s58, s58, 3375104
  s_mov_b32 s93, 0
L_pl_97:
  buffer_load_dwordx2 v[76:77], v13, s[12:15], s58 offen offset:0 sc1
  buffer_load_dwordx2 v[78:79], v13, s[12:15], s58 offen offset:2048 sc1
  s_add_u32 s59, s58, 4096
  buffer_load_dwordx2 v[80:81], v13, s[12:15], s59 offen offset:0 sc1
  buffer_load_dwordx2 v[82:83], v13, s[12:15], s59 offen offset:2048 sc1
  s_add_u32 s93, s93, 1
  s_waitcnt vmcnt(0)
  v_max3_u32 v14, v76, v77, v78
  v_max3_u32 v14, v14, v79, v80
  v_max3_u32 v14, v14, v81, v82
  v_max_u32 v14, v14, v83
  v_cmp_eq_u32 vcc, -1, v14
  s_cbranch_vccz L_pld_98
  s_cmp_gt_u32 s93, 10000
  s_cbranch_scc1 L_pld_98
  s_sleep 1
  s_branch L_pl_97
L_pld_98:
  v_add_f32 v76, v76, v78
  v_add_f32 v77, v77, v79
  v_add_f32 v80, v80, v82
  v_add_f32 v81, v81, v83
  v_add_f32 v76, v76, v80
  v_add_f32 v77, v77, v81
  v_mov_b32 v78, v76
  v_mov_b32 v79, v77
  s_nop 0
  v_permlane32_swap_b32 v76, v78
  v_permlane32_swap_b32 v77, v79
  v_add_f32 v76, v76, v78
  v_add_f32 v77, v77, v79
  v_lshlrev_b32 v12, 16, v232
  v_and_b32 v13, 0xffff0000, v232
  v_fma_f32 v12, v76, v233, v12
  v_fma_f32 v13, v77, v233, v13
  v_cvt_pk_bf16_f32 v12, v12, v13
  s_mov_b32 exec_hi, 0
  buffer_store_dword v12, v231, s[16:19], s62 offen sc1
  s_mov_b32 exec_hi, -1
L_exit:
L_exit0:
  s_endpgm
.section .rodata,"a"
.p2align 6
.amdhsa_kernel sequential_preLN__linear_kernel_hedgehog__moe_arch_mod__prompt_kernel
  .amdhsa_next_free_vgpr 256
  .amdhsa_next_free_sgpr 102
  .amdhsa_accum_offset 256
  .amdhsa_group_segment_fixed_size 0
  .amdhsa_kernarg_size 96
  .amdhsa_user_sgpr_count 2
  .amdhsa_user_sgpr_kernarg_segment_ptr 1
  .amdhsa_system_sgpr_workgroup_id_x 1
.end_amdhsa_kernel
```
